```python
import torch

def _softmax(x, axis=-1):
    return torch.softmax(x, dim=axis)
def _gelu(x):
    return torch.nn.functional.gelu(x, approximate="tanh")
def _silu(x):
    return torch.nn.functional.silu(x)
def _sigmoid(x):
    return torch.sigmoid(x)
def _layernorm(x, axis=-1, eps=1e-5):
    m = x.mean(dim=axis, keepdim=True)
    v = x.var(dim=axis, keepdim=True, unbiased=False)
    return (x - m) / torch.sqrt(v + eps)
def _scatter_add(tgt, idx, src, axis=0):
    return tgt.clone().index_add_(axis, idx, src)
def _segment_sum(src, seg, n):
    out = torch.zeros((n,) + src.shape[1:], dtype=src.dtype)
    return out.index_add_(0, seg, src)
def _pad(x, pw):
    flat = tuple(v for pair in reversed(pw) for v in pair)
    return torch.nn.functional.pad(x, flat)

kernel_name = 'gated_mix__linear_kernel_hedgehog__glu_gated_geglu__prompt'

def setup_inputs():

    _w = (lambda a: (lambda t: t.to(torch.bfloat16) if t.is_floating_point() else t)(torch.as_tensor(a)))
    def _A_setup():
        B, S, D, H = 1, 2048, 448, 16
        Dh = D // H
        return {
            "x": _w((lambda *s: torch.randn(*s, dtype=torch.bfloat16) * 0.05)(B, S, D)),
            "wqkv": _w((lambda *s: torch.randn(*s, dtype=torch.bfloat16) * 0.8)(D, 3 * D)),
            "w_phi": _w((lambda *s: torch.randn(*s, dtype=torch.bfloat16) * 0.8)(H, Dh, Dh) * (Dh ** -0.5)),
            "wo": _w((lambda *s: torch.randn(*s, dtype=torch.bfloat16) * 0.05)(D, D)),
        }
    _A_in = _A_setup()

    def _B_setup():
        B, S, Dm, Df = 1, 2048, 448, 1792
        return {
            "x": _w((lambda *s: torch.randn(*s, dtype=torch.bfloat16) * 0.05)(B, S, Dm)),
            "w_gate": _w((lambda *s: torch.randn(*s, dtype=torch.bfloat16) * 1.6)(Dm, Df) * (Dm ** -0.5)),
            "w_up": _w((lambda *s: torch.randn(*s, dtype=torch.bfloat16) * 1.6)(Dm, Df) * (Dm ** -0.5)),
            "w_down": _w((lambda *s: torch.randn(*s, dtype=torch.bfloat16) * 1.6)(Df, Dm) * (Df ** -0.5)),
        }
    _B_in = _B_setup()

    return {
        "A_x": _A_in["x"],
        "A_wqkv": _A_in["wqkv"],
        "A_w_phi": _A_in["w_phi"],
        "A_wo": _A_in["wo"],
        "B_x": _B_in["x"],
        "B_w_gate": _B_in["w_gate"],
        "B_w_up": _B_in["w_up"],
        "B_w_down": _B_in["w_down"],
        "gate_w": _w((lambda *s: torch.randn(*s, dtype=torch.bfloat16) * 0.05)(448) * 16.0),
    }

def reference(A_x, A_wqkv, A_w_phi, A_wo, B_x, B_w_gate, B_w_up, B_w_down, gate_w):
    def _A_ref(x, wqkv, w_phi, wo):
        B, S, D = x.shape
        H = 16; Dh = D // H
        qkv = (lambda x, *d: x.permute(*d))((x @ wqkv).reshape(B, S, 3, H, Dh), 2, 0, 3, 1, 4)
        q, k, v = qkv[0], qkv[1], qkv[2]
        pq = torch.einsum("bhsd,hdf->bhsf", q, w_phi)
        pk = torch.einsum("bhsd,hdf->bhsf", k, w_phi)
        phi_q = torch.concatenate([_softmax(pq, axis=-1), _softmax(-pq, axis=-1)], axis=-1)
        phi_k = torch.concatenate([_softmax(pk, axis=-1), _softmax(-pk, axis=-1)], axis=-1)
        kv = torch.einsum("bhsf,bhsd->bhfd", phi_k, v)
        z  = torch.einsum("bhsf->bhf", phi_k)
        num = torch.einsum("bhqf,bhfd->bhqd", phi_q, kv)
        den = torch.einsum("bhqf,bhf->bhq", phi_q, z)[..., None] + 1e-6
        o = num / den
        return (lambda x, *d: x.permute(*d))(o, 0, 2, 1, 3).reshape(B, S, D) @ wo

    def _B_ref(x, w_gate, w_up, w_down):
        g = torch.einsum("bsd,df->bsf", x, w_gate)
        u = torch.einsum("bsd,df->bsf", x, w_up)
        h = _gelu(g) * u
        return torch.einsum("bsf,fd->bsd", h, w_down)

    x = A_x
    g = _sigmoid((x * gate_w).sum(-1, keepdims=True))
    a = _A_ref(x, A_wqkv, A_w_phi, A_wo)
    b = _B_ref(x, B_w_gate, B_w_up, B_w_down)
    return g * a + (1 - g) * b
```

```asm
; @launch grid=(256,1,1) block=(512,1,1) lds=163840
.amdgcn_target "amdgcn-amd-amdhsa--gfx950"
.text
.globl gated_mix__linear_kernel_hedgehog__glu_gated_geglu__prompt_kernel
.p2align 8
.type gated_mix__linear_kernel_hedgehog__glu_gated_geglu__prompt_kernel,@function
gated_mix__linear_kernel_hedgehog__glu_gated_geglu__prompt_kernel:
    s_load_dwordx16 s[64:79], s[0:1], 0
    s_load_dwordx8 s[80:87], s[0:1], 64
    s_cmp_ge_u32 s2, 256
    s_cbranch_scc1 L_end
    v_lshrrev_b32 v16, 6, v0
    v_and_b32 v1, 63, v0
    v_readfirstlane_b32 s3, v16
    s_and_b32 s7, s2, 1
    s_lshl_b32 s4, s7, 3
    s_lshr_b32 s7, s2, 5
    s_add_u32 s4, s4, s7
    s_cmp_lg_u32 s3, 7
    s_cbranch_scc1 L_ow1
    s_getpc_b64 s[60:61]
L_pc0:
    s_sub_u32 s60, s60, L_pc0-gated_mix__linear_kernel_hedgehog__glu_gated_geglu__prompt_kernel
    s_subb_u32 s61, s61, 0
    s_bfe_u32 s7, s2, 0x30003
    s_lshl_b32 s7, s7, 13
    v_lshlrev_b32 v127, 7, v1
    v_add_u32 v127, s7, v127
    v_min_u32 v127, L_end-gated_mix__linear_kernel_hedgehog__glu_gated_geglu__prompt_kernel, v127
    global_load_dword v126, v127, s[60:61]
L_ow1:
    s_bfe_u32 s7, s2, 0x20001
    s_bfe_u32 s43, s2, 0x10003
    s_lshl_b32 s5, s7, 1
    s_add_u32 s5, s5, s43
    s_bfe_u32 s6, s2, 0x10004
    s_mul_i32 s7, s7, 448
    s_mul_i32 s51, s43, 320
    s_add_u32 s56, s7, s51
    s_lshl_b32 s51, s43, 5
    s_add_u32 s57, s7, s51
    s_add_u32 s57, s57, 192
    s_lshl_b32 s51, s43, 7
    s_add_u32 s51, s51, s7
    s_add_u32 s51, s51, 128
    s_cmp_eq_u32 s6, 0
    s_cselect_b32 s56, s51, s56
    s_cselect_b64 vcc, -1, 0
    s_movk_i32 s62, 1792
    s_cselect_b32 s62, 1344, s62
    s_movk_i32 s38, 768
    s_lshl_b32 s40, s3, 11
    s_lshl_b32 s41, s3, 10
    s_lshr_b32 s58, s3, 2
    v_lshrrev_b32 v16, 3, v1
    v_lshrrev_b32 v17, 4, v1
    v_and_b32 v18, 7, v1
    v_xor_b32 v18, v18, v17
    s_lshl_b32 s7, s4, 7
    s_lshl_b32 s51, s3, 4
    s_add_u32 s7, s7, s51
    v_add_u32 v16, s7, v16
    v_mul_u32_u24 v16, 896, v16
    v_lshl_add_u32 v8, v18, 4, v16
    v_xor_b32 v18, 4, v18
    v_lshl_add_u32 v9, v18, 4, v16
    v_add_u32 v9, 6144, v9
    s_mov_b32 s10, 0x1c0000
    s_mov_b32 s11, 0x20000
    v_lshrrev_b32 v16, 3, v1
    s_and_b32 s7, s3, 3
    s_lshl_b32 s7, s7, 4
    v_add_u32 v16, s7, v16
    v_mul_u32_u24 v16, 3584, v16
    v_bfe_u32 v17, v1, 1, 2
    v_bfe_u32 v18, v1, 4, 1
    v_xor_b32 v17, v17, v18
    s_lshl_b32 s7, s58, 1
    v_xor_b32 v17, s7, v17
    v_lshl_add_u32 v16, v17, 5, v16
    v_and_b32 v17, 1, v1
    v_lshl_add_u32 v16, v17, 4, v16
    s_lshl_b32 s7, s56, 1
    v_add_u32 v12, s7, v16
    v_add_u32 v13, 27648, v12
    v_lshrrev_b32 v16, 4, v1
    v_lshlrev_b32 v17, 2, v16
    v_sub_u32 v17, v1, v17
    v_and_b32 v17, 15, v17
    s_lshl_b32 s7, s3, 3
    v_add_u32 v16, s7, v16
    v_mul_u32_u24 v16, 2688, v16
    v_and_b32 v18, 7, v17
    v_min_u32 v18, 6, v18
    v_lshl_add_u32 v16, v18, 4, v16
    v_lshrrev_b32 v17, 3, v17
    v_mul_u32_u24 v17, 896, v17
    s_mul_i32 s7, s5, 112
    s_add_u32 s7, s7, 896
    v_add3_u32 v10, v16, v17, s7
    v_add_u32 v11, 9728, v10
    v_cndmask_b32 v3, v12, v10
    v_cndmask_b32 v4, v13, v11
    s_waitcnt lgkmcnt(0)
    s_mov_b32 s8, s64
    s_mov_b32 s9, s65
    s_add_u32 m0, s40, 0
    s_nop 0
    buffer_load_dwordx4 v8, s[8:11], s38 offen lds
    buffer_load_dwordx4 v9, s[8:11], s38 offen offset:1024 lds
    s_mov_b32 s12, s66
    s_mov_b32 s13, s67
    s_mov_b32 s14, 0x126000
    s_mov_b32 s15, 0x20000
    s_cmp_eq_u32 s58, 0
    s_cselect_b32 s16, s74, s76
    s_cselect_b32 s17, s75, s77
    s_mov_b32 s18, 0x188000
    s_mov_b32 s19, 0x20000
    s_cmp_eq_u32 s6, 0
    s_cselect_b32 s44, s12, s16
    s_cselect_b32 s45, s13, s17
    s_cselect_b32 s46, s14, s18
    s_mov_b32 s47, 0x20000
    s_add_u32 m0, s40, 16384
    s_mul_i32 s39, s38, s62
    buffer_load_dwordx4 v3, s[44:47], s39 offen lds
    buffer_load_dwordx4 v4, s[44:47], s39 offen offset:1024 lds
    s_lshr_b32 s7, s2, 5
    s_mul_i32 s7, s7, 1
    s_bfe_u32 s51, s2, 0x20003
    s_mul_i32 s51, s51, 2
    s_add_u32 s7, s7, s51
    s_mul_i32 s51, s7, 10923
    s_lshr_b32 s51, s51, 16
    s_mul_i32 s51, s51, 6
    s_sub_u32 s7, s7, s51
    s_lshl_b32 s32, s7, 7
    s_barrier
    s_add_u32 m0, s40, 32768
    s_nop 0
    buffer_load_dwordx4 v8, s[8:11], s32 offen lds
    buffer_load_dwordx4 v9, s[8:11], s32 offen offset:1024 lds
    s_add_u32 m0, s40, 49152
    s_mul_i32 s39, s32, s62
    buffer_load_dwordx4 v3, s[44:47], s39 offen lds
    buffer_load_dwordx4 v4, s[44:47], s39 offen offset:1024 lds
    s_add_u32 s33, s32, 128
    s_cmp_ge_u32 s33, 768
    s_cselect_b32 s33, 0, s33
    s_add_u32 s34, s33, 128
    s_cmp_ge_u32 s34, 768
    s_cselect_b32 s34, 0, s34
    s_add_u32 s35, s34, 128
    s_cmp_ge_u32 s35, 768
    s_cselect_b32 s35, 0, s35
    s_add_u32 s36, s35, 128
    s_cmp_ge_u32 s36, 768
    s_cselect_b32 s36, 0, s36
    s_add_u32 s37, s36, 128
    s_cmp_ge_u32 s37, 768
    s_cselect_b32 s37, 0, s37
    s_mov_b32 s28, s68
    s_mov_b32 s29, s69
    s_mov_b32 s30, 0x6200
    s_mov_b32 s31, 0x20000
    s_mov_b32 s20, s86
    s_mov_b32 s21, s87
    s_mov_b32 s22, 0x10000000
    s_mov_b32 s23, 0x20000
    s_mov_b32 s24, s84
    s_mov_b32 s25, s85
    s_mov_b32 s26, 0x100
    s_mov_b32 s27, 0x20000
    s_mov_b32 s88, s78
    s_mov_b32 s89, s79
    s_mov_b32 s90, 0x188000
    s_mov_b32 s91, 0x20000
    s_mov_b32 s92, s70
    s_mov_b32 s93, s71
    s_mov_b32 s94, 0x62000
    s_mov_b32 s95, 0x20000
    s_mov_b32 s96, s82
    s_mov_b32 s97, s83
    s_mov_b32 s98, 0x1c0000
    s_mov_b32 s99, 0x20000
    v_and_b32 v16, 31, v1
    v_lshrrev_b32 v17, 5, v1
    v_bfe_u32 v18, v1, 1, 3
    v_xor_b32 v18, v18, v17
    v_lshlrev_b32 v18, 4, v18
    v_lshl_add_u32 v2, v16, 7, v18
    s_and_b32 s7, s3, 3
    s_lshl_b32 s51, s7, 12
    v_add_u32 v2, s51, v2
    s_cmp_lg_u32 s6, 0
    s_cbranch_scc1 L_typeB
    v_lshrrev_b32 v16, 5, v1
    v_bfe_u32 v17, v1, 4, 1
    v_bfe_u32 v18, v1, 2, 2
    v_and_b32 v19, 3, v1
    v_lshl_add_u32 v20, v16, 3, v18
    v_lshlrev_b32 v20, 8, v20
    v_lshl_add_u32 v21, v17, 2, v19
    v_lshlrev_b32 v21, 3, v21
    s_mul_i32 s7, s58, 56
    v_add_u32 v21, s7, v21
    v_lshl_add_u32 v21, v18, 6, v21
    v_and_b32 v21, 255, v21
    v_add_u32 v44, v20, v21
    v_lshlrev_b32 v24, 4, v1
    s_and_b32 s7, s3, 3
    s_lshl_b32 s7, s7, 10
    s_add_u32 m0, s7, 148480
    s_mul_i32 s51, s5, 3136
    s_add_u32 s7, s7, s51
    buffer_load_dwordx4 v24, s[28:31], s7 offen lds
    s_or_b32 s7, s2, s3
    s_cmp_lg_u32 s7, 0
    s_cbranch_scc1 L_init18
    v_mov_b32 v26, 0
    v_lshlrev_b32 v25, 7, v1
    s_mov_b32 s7, 13631488
    buffer_store_dword v26, v25, s[20:23], s7 offen sc1
L_init18:
    s_cmp_lg_u32 s58, 0
    s_cbranch_scc1 L_pr38
    s_setprio 1
L_pr38:
    s_waitcnt vmcnt(5)
    s_barrier
    v_or_b32 v3, 16384, v44
    v_xor_b32 v4, 16512, v44
    v_xor_b32 v5, 0, v2
    ds_read_b128 v[224:227], v5
    ds_read_b64_tr_b16 v[48:49], v3
    ds_read_b64_tr_b16 v[50:51], v3 offset:1024
    ds_read_b64_tr_b16 v[52:53], v4
    ds_read_b64_tr_b16 v[54:55], v4 offset:1024
    v_xor_b32 v5, 32, v2
    ds_read_b128 v[228:231], v5
    ds_read_b64_tr_b16 v[56:57], v3 offset:4096
    ds_read_b64_tr_b16 v[58:59], v3 offset:5120
    ds_read_b64_tr_b16 v[60:61], v4 offset:4096
    ds_read_b64_tr_b16 v[62:63], v4 offset:5120
    v_xor_b32 v5, 64, v2
    s_waitcnt lgkmcnt(7)
    v_mfma_f32_32x32x16_bf16 v[64:79], v[48:51], v[224:227], 0
    ds_read_b128 v[232:235], v5
    ds_read_b64_tr_b16 v[248:249], v3 offset:8192
    ds_read_b64_tr_b16 v[250:251], v3 offset:9216
    s_waitcnt lgkmcnt(8)
    s_add_u32 m0, s40, 65536
    s_nop 0
    buffer_load_dwordx4 v8, s[8:11], s33 offen lds
    s_mov_b32 s48, 0x3fb8aa3b
    s_mov_b32 s49, 0xbdd2d3e8
    v_mov_b32 v47, 0xc0135761
    s_mov_b32 s52, 0
    s_mov_b32 s53, -1
    s_mov_b32 s54, 0x10000000
    s_mov_b32 s55, 0x10000000
    s_and_b32 s7, s3, 3
    s_mul_i32 s51, s7, 147456
    v_lshlrev_b32 v7, 4, v1
    v_add_u32 v7, s51, v7
    s_mul_i32 s42, s4, 589824
    v_cndmask_b32_e64 v42, 1.0, 0, s[52:53]
    v_mfma_f32_32x32x16_bf16 v[80:95], v[224:227], v[52:55], 0
    ds_read_b64_tr_b16 v[48:49], v4 offset:8192
    ds_read_b64_tr_b16 v[50:51], v4 offset:9216
    s_waitcnt lgkmcnt(7)
    buffer_load_dwordx4 v9, s[8:11], s33 offen offset:1024 lds
    s_lshl_b32 s59, s56, 6
    s_add_u32 s59, s59, s42
    s_add_u32 s59, s59, 32768
    s_lshl_b32 s51, s58, 11
    s_add_u32 s59, s59, s51
    s_lshl_b32 s60, s57, 6
    s_add_u32 s60, s60, s42
    s_add_u32 s60, s60, 32768
    s_lshl_b32 s51, s58, 10
    v_xor_b32 v5, 96, v2
    v_mfma_f32_32x32x16_bf16 v[64:79], v[56:59], v[228:231], v[64:79]
    ds_read_b128 v[236:239], v5
    ds_read_b64_tr_b16 v[52:53], v3 offset:12288
    ds_read_b64_tr_b16 v[54:55], v3 offset:13312
    s_waitcnt lgkmcnt(8)
    s_add_u32 m0, s40, 81920
    s_mul_i32 s39, s33, 1344
    buffer_load_dwordx4 v10, s[12:15], s39 offen lds
    s_add_u32 s60, s60, s51
    s_lshr_b32 s7, s2, 3
    s_and_b32 s51, s7, 1
    s_lshr_b32 s43, s7, 2
    s_lshl_b32 s43, s43, 1
    s_add_u32 s51, s51, s43
    s_sub_u32 s43, s7, 4
    s_cmp_lt_u32 s7, 8
    s_cselect_b32 s43, s51, s43
    s_cselect_b32 s63, 1, 0
    s_waitcnt vmcnt(4)
    s_barrier
    v_mfma_f32_32x32x16_bf16 v[80:95], v[228:231], v[60:63], v[80:95]
    ds_read_b64_tr_b16 v[56:57], v4 offset:12288
    ds_read_b64_tr_b16 v[58:59], v4 offset:13312
    s_waitcnt lgkmcnt(7)
    buffer_load_dwordx4 v11, s[12:15], s39 offen offset:1024 lds
    s_cmp_eq_u32 s6, 0
    s_cselect_b32 s63, s63, 0
    s_mul_i32 s51, s43, 37
    s_lshr_b32 s51, s51, 8
    s_mul_i32 s62, s51, 7
    s_sub_u32 s62, s43, s62
    s_and_b32 s61, s2, 7
    s_lshl_b32 s61, s61, 2
    s_add_u32 s61, s61, s51
    v_or_b32 v3, 49152, v44
    v_xor_b32 v4, 49280, v44
    v_xor_b32 v5, 32768, v2
    v_mfma_f32_32x32x16_bf16 v[64:79], v[248:251], v[232:235], v[64:79]
    ds_read_b128 v[128:131], v5
    ds_read_b64_tr_b16 v[60:61], v3
    ds_read_b64_tr_b16 v[62:63], v3 offset:1024
    s_waitcnt lgkmcnt(8)
    s_add_u32 m0, s40, 98304
    s_nop 0
    buffer_load_dwordx4 v8, s[8:11], s34 offen lds
    s_bfe_u32 s70, s3, 0x10001
    s_add_u32 s7, s61, s62
    s_add_u32 s84, s7, 0
    s_and_b32 s84, s84, 3
    s_add_u32 s85, s7, 1
    s_and_b32 s85, s85, 3
    s_add_u32 s86, s7, 2
    s_and_b32 s86, s86, 3
    s_add_u32 s87, s7, 3
    v_mfma_f32_32x32x16_bf16 v[80:95], v[232:235], v[48:51], v[80:95]
    ds_read_b64_tr_b16 v[248:249], v4
    ds_read_b64_tr_b16 v[250:251], v4 offset:1024
    s_waitcnt lgkmcnt(7)
    buffer_load_dwordx4 v9, s[8:11], s34 offen offset:1024 lds
    s_and_b32 s87, s87, 3
    s_and_b32 s64, s7, 1
    s_xor_b32 s65, s64, 1
    s_lshl_b32 s66, s5, 18
    s_lshl_b32 s7, s4, 10
    s_add_u32 s66, s66, s7
    s_lshl_b32 s51, s3, 7
    s_add_u32 s66, s66, s51
    s_add_u32 s66, s66, 10485760
    v_xor_b32 v5, 32800, v2
    v_mfma_f32_32x32x16_bf16 v[64:79], v[52:55], v[236:239], v[64:79]
    ds_read_b128 v[132:135], v5
    ds_read_b64_tr_b16 v[48:49], v3 offset:4096
    ds_read_b64_tr_b16 v[50:51], v3 offset:5120
    s_waitcnt lgkmcnt(8)
    s_add_u32 m0, s40, 114688
    s_mul_i32 s39, s34, 1344
    buffer_load_dwordx4 v10, s[12:15], s39 offen lds
    s_lshl_b32 s67, s5, 13
    s_add_u32 s67, s67, 12582912
    s_lshl_b32 s7, s58, 12
    s_add_u32 s77, s67, s7
    s_add_u32 s67, s67, s51
    s_lshr_b32 s7, s4, 1
    s_lshl_b32 s7, s7, 10
    s_add_u32 s67, s67, s7
    s_and_b32 s7, s4, 1
    v_mfma_f32_32x32x16_bf16 v[80:95], v[236:239], v[56:59], v[80:95]
    ds_read_b64_tr_b16 v[52:53], v4 offset:4096
    ds_read_b64_tr_b16 v[54:55], v4 offset:5120
    s_waitcnt lgkmcnt(7)
    buffer_load_dwordx4 v11, s[12:15], s39 offen offset:1024 lds
    s_lshl_b32 s7, s7, 3
    s_add_u32 s67, s67, s7
    s_lshl_b32 s68, s5, 12
    s_lshl_b32 s7, s58, 11
    s_add_u32 s68, s68, s7
    s_add_u32 s68, s68, s42
    s_lshl_b32 s76, s4, 9
    s_and_b32 s7, s3, 3
    s_lshl_b32 s7, s7, 7
    v_xor_b32 v5, 32832, v2
    v_mfma_f32_32x32x16_bf16 v[64:79], v[60:63], v[128:131], v[64:79]
    ds_read_b128 v[136:139], v5
    ds_read_b64_tr_b16 v[56:57], v3 offset:8192
    ds_read_b64_tr_b16 v[58:59], v3 offset:9216
    s_waitcnt lgkmcnt(8)
    s_add_u32 m0, s40, 131072
    s_nop 0
    buffer_load_dwordx4 v8, s[8:11], s35 offen lds
    s_add_u32 s76, s76, s7
    s_add_u32 s76, s76, 13697024
    s_lshl_b32 s79, s61, 8
    s_lshl_b32 s7, s58, 7
    s_add_u32 s79, s79, s7
    s_add_u32 s79, s79, 13697024
    s_and_b32 s7, s4, 3
    s_lshl_b32 s51, s58, 2
    s_or_b32 s7, s7, s51
    v_mfma_f32_32x32x16_bf16 v[80:95], v[128:131], v[248:251], v[80:95]
    ds_read_b64_tr_b16 v[60:61], v4 offset:8192
    ds_read_b64_tr_b16 v[62:63], v4 offset:9216
    s_waitcnt lgkmcnt(7)
    buffer_load_dwordx4 v9, s[8:11], s35 offen offset:1024 lds
    s_cmp_eq_u32 s7, 7
    s_cselect_b32 s78, 0, -1
    v_mov_b32 v252, -1
    v_mov_b32 v253, -1
    v_mov_b32 v254, -1
    v_mov_b32 v255, -1
    s_lshl_b32 s80, s4, 7
    s_add_u32 s80, s80, 13631488
    s_lshr_b32 s81, s61, 1
    s_lshl_b32 s81, s81, 7
    s_add_u32 s81, s81, 13631488
    s_lshl_b32 s82, s5, 7
    s_add_u32 s82, s82, 13633536
    v_xor_b32 v5, 32864, v2
    v_mfma_f32_32x32x16_bf16 v[64:79], v[48:51], v[132:135], v[64:79]
    ds_read_b128 v[140:143], v5
    ds_read_b64_tr_b16 v[248:249], v3 offset:12288
    ds_read_b64_tr_b16 v[250:251], v3 offset:13312
    s_waitcnt lgkmcnt(8)
    s_lshl_b32 s7, s61, 1
    s_add_u32 s7, s7, s58
    s_mul_i32 s7, s7, 147456
    s_and_b32 s51, s3, 1
    s_lshl_b32 s51, s51, 11
    s_add_u32 s7, s7, s51
    s_lshl_b32 s51, s63, 30
    s_lshl_b32 s51, s51, 0
    s_add_u32 s7, s7, s51
    v_lshlrev_b32 v6, 4, v1
    v_add_u32 v6, s7, v6
    v_lshrrev_b32 v16, 5, v1
    v_bfe_u32 v17, v1, 4, 1
    v_bfe_u32 v18, v1, 2, 2
    s_waitcnt vmcnt(10)
    s_waitcnt vmcnt(6)
    s_barrier
    s_or_b32 s73, s2, s3
    s_cmp_lg_u32 s73, 0
    s_cbranch_scc1 L_init19
    v_mov_b32 v31, 1
    buffer_store_dword v31, off, s[24:27], 0 sc1
L_init19:
    v_mfma_f32_32x32x16_bf16 v[80:95], v[132:135], v[52:55], v[80:95]
    ds_read_b64_tr_b16 v[48:49], v4 offset:12288
    ds_read_b64_tr_b16 v[50:51], v4 offset:13312
    s_waitcnt lgkmcnt(7)
    s_add_u32 m0, s40, 0
    s_mul_i32 s39, s35, 1344
    buffer_load_dwordx4 v10, s[12:15], s39 offen lds
    v_and_b32 v19, 3, v1
    v_lshl_add_u32 v20, v16, 2, v18
    v_or_b32 v3, 81920, v44
    v_xor_b32 v4, 82048, v44
    v_xor_b32 v5, 65536, v2
    v_mfma_f32_32x32x16_bf16 v[64:79], v[56:59], v[136:139], v[64:79]
    ds_read_b128 v[144:147], v5
    ds_read_b64_tr_b16 v[52:53], v3
    ds_read_b64_tr_b16 v[54:55], v3 offset:1024
    s_waitcnt lgkmcnt(8)
    buffer_load_dwordx4 v11, s[12:15], s39 offen offset:1024 lds
    v_lshlrev_b32 v20, 7, v20
    v_lshrrev_b32 v21, 1, v18
    v_lshl_add_u32 v20, v21, 6, v20
    v_lshl_add_u32 v21, v17, 2, v19
    v_lshl_add_u32 v20, v21, 3, v20
    s_and_b32 s7, s3, 3
    s_lshl_b32 s7, s7, 12
    v_mfma_f32_32x32x16_bf16 v[80:95], v[136:139], v[60:63], v[80:95]
    ds_read_b64_tr_b16 v[56:57], v4
    ds_read_b64_tr_b16 v[58:59], v4 offset:1024
    s_waitcnt lgkmcnt(7)
    s_add_u32 m0, s40, 16384
    s_nop 0
    buffer_load_dwordx4 v8, s[8:11], s36 offen lds
    v_add_u32 v14, s7, v20
    v_lshrrev_b32 v16, 2, v1
    s_and_b32 s7, s3, 3
    s_lshl_b32 s7, s7, 4
    v_add_u32 v16, s7, v16
    v_mul_u32_u24 v16, 3584, v16
    v_xor_b32 v5, 65568, v2
    v_mfma_f32_32x32x16_bf16 v[64:79], v[248:251], v[140:143], v[64:79]
    ds_read_b128 v[148:151], v5
    ds_read_b64_tr_b16 v[60:61], v3 offset:4096
    ds_read_b64_tr_b16 v[62:63], v3 offset:5120
    s_waitcnt lgkmcnt(8)
    buffer_load_dwordx4 v9, s[8:11], s36 offen offset:1024 lds
    v_and_b32 v17, 3, v1
    s_lshl_b32 s7, s58, 1
    v_xor_b32 v17, s7, v17
    v_lshl_add_u32 v16, v17, 4, v16
    s_lshl_b32 s7, s57, 1
    v_add_u32 v43, s7, v16
    v_lshrrev_b32 v16, 5, v1
    v_mfma_f32_32x32x16_bf16 v[80:95], v[140:143], v[48:51], v[80:95]
    ds_read_b64_tr_b16 v[248:249], v4 offset:4096
    ds_read_b64_tr_b16 v[250:251], v4 offset:5120
    s_waitcnt lgkmcnt(7)
    v_bfe_u32 v17, v1, 4, 1
    v_bfe_u32 v18, v1, 2, 2
    v_and_b32 v19, 3, v1
    v_lshl_add_u32 v20, v16, 3, v18
    v_xor_b32 v5, 65600, v2
    v_mfma_f32_32x32x16_bf16 v[64:79], v[52:55], v[144:147], v[64:79]
    ds_read_b128 v[152:155], v5
    ds_read_b64_tr_b16 v[48:49], v3 offset:8192
    ds_read_b64_tr_b16 v[50:51], v3 offset:9216
    s_waitcnt lgkmcnt(8)
    v_lshlrev_b32 v20, 7, v20
    v_lshl_add_u32 v20, v17, 13, v20
    v_lshrrev_b32 v21, 1, v18
    v_lshl_add_u32 v21, v17, 1, v21
    s_lshl_b32 s7, s58, 1
    v_xor_b32 v21, s7, v21
    v_mfma_f32_32x32x16_bf16 v[80:95], v[144:147], v[56:59], v[80:95]
    ds_read_b64_tr_b16 v[52:53], v4 offset:8192
    ds_read_b64_tr_b16 v[54:55], v4 offset:9216
    s_waitcnt lgkmcnt(7)
    v_lshl_add_u32 v20, v21, 5, v20
    v_lshl_add_u32 v45, v19, 3, v20
    v_lshrrev_b32 v16, 5, v1
    v_bfe_u32 v17, v1, 4, 1
    v_xor_b32 v5, 65632, v2
    v_mfma_f32_32x32x16_bf16 v[64:79], v[60:63], v[148:151], v[64:79]
    ds_read_b128 v[156:159], v5
    ds_read_b64_tr_b16 v[56:57], v3 offset:12288
    ds_read_b64_tr_b16 v[58:59], v3 offset:13312
    s_waitcnt lgkmcnt(8)
    v_bfe_u32 v18, v1, 2, 2
    v_and_b32 v19, 3, v1
    v_lshl_add_u32 v20, v16, 3, v18
    v_lshlrev_b32 v20, 6, v20
    v_lshl_add_u32 v20, v17, 12, v20
    s_waitcnt vmcnt(6)
    s_barrier
    v_mfma_f32_32x32x16_bf16 v[80:95], v[148:151], v[248:251], v[80:95]
    ds_read_b64_tr_b16 v[60:61], v4 offset:12288
    ds_read_b64_tr_b16 v[62:63], v4 offset:13312
    s_waitcnt lgkmcnt(7)
    s_add_u32 m0, s40, 32768
    s_mul_i32 s39, s36, 1344
    buffer_load_dwordx4 v10, s[12:15], s39 offen lds
    v_xor_b32 v21, s58, v17
    v_lshl_add_u32 v20, v21, 5, v20
    v_or_b32 v3, 114688, v44
    v_xor_b32 v4, 114816, v44
    v_xor_b32 v5, 98304, v2
    v_mfma_f32_32x32x16_bf16 v[64:79], v[48:51], v[152:155], v[64:79]
    ds_read_b128 v[160:163], v5
    ds_read_b64_tr_b16 v[248:249], v3
    ds_read_b64_tr_b16 v[250:251], v3 offset:1024
    s_waitcnt lgkmcnt(8)
    buffer_load_dwordx4 v11, s[12:15], s39 offen offset:1024 lds
    v_lshl_add_u32 v46, v19, 3, v20
    v_mfma_f32_32x32x16_bf16 v[80:95], v[152:155], v[52:55], v[80:95]
    ds_read_b64_tr_b16 v[48:49], v4
    ds_read_b64_tr_b16 v[50:51], v4 offset:1024
    s_waitcnt lgkmcnt(7)
    s_add_u32 m0, s40, 49152
    s_nop 0
    buffer_load_dwordx4 v8, s[8:11], s37 offen lds
    v_lshrrev_b32 v16, 5, v1
    v_bfe_u32 v17, v1, 4, 1
    v_bfe_u32 v18, v1, 2, 2
    v_xor_b32 v5, 98336, v2
    v_mfma_f32_32x32x16_bf16 v[64:79], v[56:59], v[156:159], v[64:79]
    ds_read_b128 v[164:167], v5
    ds_read_b64_tr_b16 v[52:53], v3 offset:4096
    ds_read_b64_tr_b16 v[54:55], v3 offset:5120
    s_waitcnt lgkmcnt(8)
    buffer_load_dwordx4 v9, s[8:11], s37 offen offset:1024 lds
    v_and_b32 v19, 3, v1
    v_lshl_add_u32 v20, v16, 2, v18
    v_mul_u32_u24 v20, 56, v20
    v_lshl_add_u32 v21, v17, 2, v19
    v_mfma_f32_32x32x16_bf16 v[80:95], v[156:159], v[60:63], v[80:95]
    ds_read_b64_tr_b16 v[56:57], v4 offset:4096
    ds_read_b64_tr_b16 v[58:59], v4 offset:5120
    s_waitcnt lgkmcnt(7)
    v_min_u32 v21, 6, v21
    v_lshl_add_u32 v20, v21, 3, v20
    s_mul_i32 s71, s58, 1568
    s_add_u32 s71, s71, 148480
    v_add_u32 v20, s71, v20
    v_xor_b32 v5, 98368, v2
    v_mfma_f32_32x32x16_bf16 v[64:79], v[248:251], v[160:163], v[64:79]
    ds_read_b128 v[168:171], v5
    ds_read_b64_tr_b16 v[60:61], v3 offset:8192
    ds_read_b64_tr_b16 v[62:63], v3 offset:9216
    s_waitcnt lgkmcnt(8)
    ds_read_b64_tr_b16 v[240:241], v20
    ds_read_b64_tr_b16 v[242:243], v20 offset:448
    ds_read_b64_tr_b16 v[244:245], v20 offset:896
    ds_read_b64_tr_b16 v[246:247], v20 offset:1344
    v_mov_b32 v21, 0
    v_mfma_f32_32x32x16_bf16 v[80:95], v[160:163], v[48:51], v[80:95]
    ds_read_b64_tr_b16 v[248:249], v4 offset:8192
    ds_read_b64_tr_b16 v[250:251], v4 offset:9216
    s_waitcnt lgkmcnt(11)
    v_xor_b32 v5, 98400, v2
    v_mfma_f32_32x32x16_bf16 v[64:79], v[52:55], v[164:167], v[64:79]
    ds_read_b128 v[172:175], v5
    ds_read_b64_tr_b16 v[48:49], v3 offset:12288
    ds_read_b64_tr_b16 v[50:51], v3 offset:13312
    s_waitcnt lgkmcnt(12)
    s_waitcnt lgkmcnt(5)
    v_cndmask_b32_e64 v246, v246, v21, s[52:53]
    v_cndmask_b32_e64 v247, v247, v21, s[52:53]
    s_waitcnt vmcnt(6)
    s_barrier
    v_mfma_f32_32x32x16_bf16 v[80:95], v[164:167], v[56:59], v[80:95]
    ds_read_b64_tr_b16 v[52:53], v4 offset:12288
    ds_read_b64_tr_b16 v[54:55], v4 offset:13312
    s_add_u32 m0, s40, 65536
    s_mul_i32 s39, s37, 1344
    buffer_load_dwordx4 v10, s[12:15], s39 offen lds
    s_mul_i32 s50, s58, 16384
    s_add_u32 s50, s50, 49152
    v_and_b32 v32, 5, v1
    v_or_b32 v3, 0, v44
    v_xor_b32 v4, 128, v44
    v_xor_b32 v5, 131072, v2
    v_mfma_f32_32x32x16_bf16 v[64:79], v[60:63], v[168:171], v[64:79]
    ds_read_b128 v[176:179], v5
    ds_read_b64_tr_b16 v[56:57], v3
    ds_read_b64_tr_b16 v[58:59], v3 offset:1024
    s_waitcnt lgkmcnt(8)
    v_bfe_u32 v33, v1, 3, 1
    v_lshl_or_b32 v32, v33, 1, v32
    v_bfe_u32 v33, v1, 1, 1
    v_lshl_or_b32 v32, v33, 3, v32
    v_mfma_f32_32x32x16_bf16 v[80:95], v[168:171], v[248:251], v[80:95]
    ds_read_b64_tr_b16 v[60:61], v4
    ds_read_b64_tr_b16 v[62:63], v4 offset:1024
    s_waitcnt lgkmcnt(7)
    buffer_load_dwordx4 v11, s[12:15], s39 offen offset:1024 lds
    v_lshrrev_b32 v33, 5, v1
    v_xor_b32 v32, v32, v33
    v_lshlrev_b32 v32, 3, v32
    v_xor_b32 v5, 131104, v2
    v_mfma_f32_32x32x16_bf16 v[64:79], v[48:51], v[172:175], v[64:79]
    ds_read_b128 v[180:183], v5
    ds_read_b64_tr_b16 v[248:249], v3 offset:4096
    ds_read_b64_tr_b16 v[250:251], v3 offset:5120
    s_waitcnt lgkmcnt(8)
    v_and_b32 v33, 0x3f80, v2
    v_add3_u32 v15, v32, v33, s50
    v_lshrrev_b32 v32, 5, v1
    v_bfe_u32 v33, v1, 4, 1
    v_mfma_f32_32x32x16_bf16 v[80:95], v[172:175], v[52:55], v[80:95]
    ds_read_b64_tr_b16 v[48:49], v4 offset:4096
    ds_read_b64_tr_b16 v[50:51], v4 offset:5120
    s_waitcnt lgkmcnt(7)
    s_add_u32 m0, s40, 81920
    s_mul_i32 s39, s32, 1792
    buffer_load_dwordx4 v12, s[16:19], s39 offen lds
    v_bfe_u32 v34, v1, 2, 2
    v_and_b32 v35, 3, v1
    v_lshl_add_u32 v36, v33, 2, v35
    s_and_b32 s71, s3, 1
    s_lshl_b32 s71, s71, 3
    v_xor_b32 v5, 131136, v2
    v_mfma_f32_32x32x16_bf16 v[64:79], v[56:59], v[176:179], v[64:79]
    ds_read_b128 v[184:187], v5
    ds_read_b64_tr_b16 v[52:53], v3 offset:8192
    ds_read_b64_tr_b16 v[54:55], v3 offset:9216
    s_waitcnt lgkmcnt(8)
    v_or_b32 v36, s71, v36
    v_and_b32 v37, 1, v34
    v_lshl_or_b32 v37, v32, 2, v37
    v_lshrrev_b32 v38, 1, v34
    v_mfma_f32_32x32x16_bf16 v[80:95], v[176:179], v[60:63], v[80:95]
    ds_read_b64_tr_b16 v[56:57], v4 offset:8192
    ds_read_b64_tr_b16 v[58:59], v4 offset:9216
    s_waitcnt lgkmcnt(7)
    buffer_load_dwordx4 v13, s[16:19], s39 offen offset:1024 lds
    v_lshl_or_b32 v37, v38, 3, v37
    v_xor_b32 v36, v36, v37
    v_lshlrev_b32 v36, 3, v36
    v_xor_b32 v5, 131168, v2
    v_mfma_f32_32x32x16_bf16 v[64:79], v[248:251], v[180:183], v[64:79]
    ds_read_b128 v[188:191], v5
    ds_read_b64_tr_b16 v[60:61], v3 offset:12288
    ds_read_b64_tr_b16 v[62:63], v3 offset:13312
    s_waitcnt lgkmcnt(8)
    v_lshl_add_u32 v37, v32, 2, v34
    v_lshl_add_u32 v36, v37, 7, v36
    v_add_u32 v40, s50, v36
    s_lshl_b32 s71, s58, 13
    s_add_u32 s71, s71, 147456
    v_lshl_add_u32 v41, v1, 4, s71
    s_lshl_b32 s71, s5, 4
    s_add_u32 s71, s71, s4
    s_lshl_b32 s71, s71, 14
    s_lshl_b32 s72, s58, 13
    s_add_u32 s71, s71, s72
    s_and_b32 s72, s3, 1
    s_lshl_b32 s72, s72, 12
    s_add_u32 s71, s71, s72
    s_add_u32 s50, s71, 10485760
    s_waitcnt vmcnt(6)
    s_barrier
    v_mfma_f32_32x32x16_bf16 v[80:95], v[180:183], v[48:51], v[80:95]
    ds_read_b64_tr_b16 v[248:249], v4 offset:12288
    ds_read_b64_tr_b16 v[250:251], v4 offset:13312
    s_waitcnt lgkmcnt(7)
    s_add_u32 m0, s40, 98304
    s_mul_i32 s39, s33, 1792
    buffer_load_dwordx4 v12, s[16:19], s39 offen lds
    v_mov_b32 v39, 0x3f803f80
    s_add_u32 s71, s40, 147456
    v_or_b32 v3, 32768, v44
    v_xor_b32 v4, 32896, v44
    v_xor_b32 v5, 16384, v2
    v_mfma_f32_32x32x16_bf16 v[64:79], v[52:55], v[184:187], v[64:79]
    ds_read_b128 v[192:195], v5
    ds_read_b64_tr_b16 v[48:49], v3
    ds_read_b64_tr_b16 v[50:51], v3 offset:1024
    s_waitcnt lgkmcnt(8)
    v_lshl_add_u32 v38, v1, 4, s71
    v_mfma_f32_32x32x16_bf16 v[80:95], v[184:187], v[56:59], v[80:95]
    ds_read_b64_tr_b16 v[52:53], v4
    ds_read_b64_tr_b16 v[54:55], v4 offset:1024
    s_waitcnt lgkmcnt(7)
    buffer_load_dwordx4 v13, s[16:19], s39 offen offset:1024 lds
    v_xor_b32 v5, 16416, v2
    v_mfma_f32_32x32x16_bf16 v[64:79], v[60:63], v[188:191], v[64:79]
    ds_read_b128 v[196:199], v5
    ds_read_b64_tr_b16 v[56:57], v3 offset:4096
    ds_read_b64_tr_b16 v[58:59], v3 offset:5120
    s_waitcnt lgkmcnt(8)
    v_mfma_f32_32x32x16_bf16 v[80:95], v[188:191], v[248:251], v[80:95]
    ds_read_b64_tr_b16 v[60:61], v4 offset:4096
    ds_read_b64_tr_b16 v[62:63], v4 offset:5120
    s_waitcnt lgkmcnt(7)
    s_add_u32 m0, s40, 114688
    s_mul_i32 s39, s34, 1792
    buffer_load_dwordx4 v12, s[16:19], s39 offen lds
    v_xor_b32 v5, 16448, v2
    v_mfma_f32_32x32x16_bf16 v[64:79], v[48:51], v[192:195], v[64:79]
    ds_read_b128 v[200:203], v5
    ds_read_b64_tr_b16 v[248:249], v3 offset:8192
    ds_read_b64_tr_b16 v[250:251], v3 offset:9216
    s_waitcnt lgkmcnt(8)
    v_mfma_f32_32x32x16_bf16 v[80:95], v[192:195], v[52:55], v[80:95]
    ds_read_b64_tr_b16 v[48:49], v4 offset:8192
    ds_read_b64_tr_b16 v[50:51], v4 offset:9216
    s_waitcnt lgkmcnt(7)
    buffer_load_dwordx4 v13, s[16:19], s39 offen offset:1024 lds
    v_xor_b32 v5, 16480, v2
    v_mfma_f32_32x32x16_bf16 v[64:79], v[56:59], v[196:199], v[64:79]
    ds_read_b128 v[204:207], v5
    ds_read_b64_tr_b16 v[52:53], v3 offset:12288
    ds_read_b64_tr_b16 v[54:55], v3 offset:13312
    s_waitcnt lgkmcnt(8)
    s_waitcnt vmcnt(6)
    s_barrier
    v_mfma_f32_32x32x16_bf16 v[80:95], v[196:199], v[60:63], v[80:95]
    ds_read_b64_tr_b16 v[56:57], v4 offset:12288
    ds_read_b64_tr_b16 v[58:59], v4 offset:13312
    s_waitcnt lgkmcnt(7)
    s_add_u32 m0, s40, 131072
    s_mul_i32 s39, s35, 1792
    buffer_load_dwordx4 v12, s[16:19], s39 offen lds
    v_or_b32 v3, 65536, v44
    v_xor_b32 v4, 65664, v44
    v_xor_b32 v5, 49152, v2
    v_mfma_f32_32x32x16_bf16 v[64:79], v[248:251], v[200:203], v[64:79]
    ds_read_b128 v[208:211], v5
    ds_read_b64_tr_b16 v[60:61], v3
    ds_read_b64_tr_b16 v[62:63], v3 offset:1024
    s_waitcnt lgkmcnt(8)
    v_mfma_f32_32x32x16_bf16 v[80:95], v[200:203], v[48:51], v[80:95]
    ds_read_b64_tr_b16 v[248:249], v4
    ds_read_b64_tr_b16 v[250:251], v4 offset:1024
    s_waitcnt lgkmcnt(7)
    buffer_load_dwordx4 v13, s[16:19], s39 offen offset:1024 lds
    v_xor_b32 v5, 49184, v2
    v_mfma_f32_32x32x16_bf16 v[64:79], v[52:55], v[204:207], v[64:79]
    ds_read_b128 v[212:215], v5
    ds_read_b64_tr_b16 v[48:49], v3 offset:4096
    ds_read_b64_tr_b16 v[50:51], v3 offset:5120
    s_waitcnt lgkmcnt(8)
    v_mfma_f32_32x32x16_bf16 v[80:95], v[204:207], v[56:59], v[80:95]
    ds_read_b64_tr_b16 v[52:53], v4 offset:4096
    ds_read_b64_tr_b16 v[54:55], v4 offset:5120
    s_waitcnt lgkmcnt(7)
    s_add_u32 m0, s40, 0
    s_mul_i32 s39, s36, 1792
    buffer_load_dwordx4 v12, s[16:19], s39 offen lds
    v_xor_b32 v5, 49216, v2
    v_mfma_f32_32x32x16_bf16 v[64:79], v[60:63], v[208:211], v[64:79]
    ds_read_b128 v[216:219], v5
    ds_read_b64_tr_b16 v[56:57], v3 offset:8192
    ds_read_b64_tr_b16 v[58:59], v3 offset:9216
    s_waitcnt lgkmcnt(8)
    v_mfma_f32_32x32x16_bf16 v[80:95], v[208:211], v[248:251], v[80:95]
    ds_read_b64_tr_b16 v[60:61], v4 offset:8192
    ds_read_b64_tr_b16 v[62:63], v4 offset:9216
    s_waitcnt lgkmcnt(7)
    buffer_load_dwordx4 v13, s[16:19], s39 offen offset:1024 lds
    v_xor_b32 v5, 49248, v2
    v_mfma_f32_32x32x16_bf16 v[64:79], v[48:51], v[212:215], v[64:79]
    ds_read_b128 v[220:223], v5
    ds_read_b64_tr_b16 v[248:249], v3 offset:12288
    ds_read_b64_tr_b16 v[250:251], v3 offset:13312
    s_waitcnt lgkmcnt(8)
    v_lshrrev_b32 v16, 3, v1
    v_mul_u32_u24 v16, 896, v16
    v_bfe_u32 v17, v1, 4, 1
    s_waitcnt vmcnt(8)
    s_barrier
    v_mfma_f32_32x32x16_bf16 v[80:95], v[212:215], v[52:55], v[80:95]
    ds_read_b64_tr_b16 v[48:49], v4 offset:12288
    ds_read_b64_tr_b16 v[50:51], v4 offset:13312
    s_waitcnt lgkmcnt(7)
    s_add_u32 m0, s40, 16384
    s_mul_i32 s39, s37, 1792
    buffer_load_dwordx4 v12, s[16:19], s39 offen lds
    v_lshlrev_b32 v17, 2, v17
    v_or_b32 v3, 81920, v45
    v_xor_b32 v4, 81952, v45
    v_mfma_f32_32x32x16_bf16 v[64:79], v[56:59], v[216:219], v[64:79]
    ds_read_b64_tr_b16 v[52:53], v3
    ds_read_b64_tr_b16 v[54:55], v3 offset:512
    s_waitcnt lgkmcnt(7)
    v_and_b32 v18, 7, v1
    v_xor_b32 v17, v17, v18
    v_lshl_add_u32 v16, v17, 4, v16
    s_lshl_b32 s71, s62, 7
    s_lshl_b32 s72, s63, 30
    s_lshl_b32 s72, s72, 0
    s_add_u32 s71, s71, s72
    s_and_b32 s72, s3, 3
    s_mul_i32 s72, s72, 14336
    s_add_u32 s72, s72, s71
    v_mfma_f32_32x32x16_bf16 v[80:95], v[216:219], v[60:63], v[80:95]
    ds_read_b64_tr_b16 v[56:57], v4
    ds_read_b64_tr_b16 v[58:59], v4 offset:512
    s_waitcnt lgkmcnt(6)
    buffer_load_dwordx4 v13, s[16:19], s39 offen offset:1024 lds
    v_add_u32 v8, s72, v16
    v_add_u32 v9, 6144, v8
    s_mul_i32 s72, s70, 25088
    s_add_u32 s71, s71, s72
    s_and_b32 s72, s3, 1
    s_mul_i32 s72, s72, 14336
    s_add_u32 s71, s71, s72
    v_add_u32 v10, s71, v16
    v_mfma_f32_32x32x16_bf16 v[64:79], v[248:251], v[220:223], v[64:79]
    ds_read_b64_tr_b16 v[60:61], v3 offset:2048
    ds_read_b64_tr_b16 v[62:63], v3 offset:2560
    s_waitcnt lgkmcnt(6)
    v_add_u32 v11, 6144, v10
    v_mfma_f32_32x32x16_bf16 v[80:95], v[220:223], v[48:51], v[80:95]
    ds_read_b64_tr_b16 v[248:249], v4 offset:2048
    ds_read_b64_tr_b16 v[250:251], v4 offset:2560
    s_waitcnt lgkmcnt(6)
    s_add_u32 m0, s40, 32768
    s_mul_i32 s39, s38, 1792
    buffer_load_dwordx4 v12, s[16:19], s39 offen lds
    v_mfma_f32_32x32x16_bf16 v[96:111], v[52:55], v[128:131], 0
    ds_read_b64_tr_b16 v[48:49], v3 offset:4096
    ds_read_b64_tr_b16 v[50:51], v3 offset:4608
    s_waitcnt lgkmcnt(6)
    v_mfma_f32_32x32x16_bf16 v[112:127], v[56:59], v[128:131], 0
    ds_read_b64_tr_b16 v[52:53], v4 offset:4096
    ds_read_b64_tr_b16 v[54:55], v4 offset:4608
    s_waitcnt lgkmcnt(6)
    buffer_load_dwordx4 v13, s[16:19], s39 offen offset:1024 lds
    v_cvt_pk_bf16_f32 v16, v64, v65
    v_cvt_pk_bf16_f32 v17, v66, v67
    v_cvt_pk_bf16_f32 v18, v68, v69
    v_cvt_pk_bf16_f32 v19, v70, v71
    v_cvt_pk_bf16_f32 v20, v72, v73
    v_cvt_pk_bf16_f32 v21, v74, v75
    buffer_store_dwordx4 v[252:255], v7, s[20:23], s59 offen sc1
    v_mfma_f32_32x32x16_bf16 v[96:111], v[60:63], v[132:135], v[96:111]
    ds_read_b64_tr_b16 v[56:57], v3 offset:6144
    ds_read_b64_tr_b16 v[58:59], v3 offset:6656
    s_waitcnt lgkmcnt(6)
    v_cvt_pk_bf16_f32 v22, v76, v77
    v_cvt_pk_bf16_f32 v23, v78, v79
    v_cvt_pk_bf16_f32 v24, v80, v81
    v_cvt_pk_bf16_f32 v25, v82, v83
    v_mfma_f32_32x32x16_bf16 v[64:79], v[240:243], v[16:19], 0
    v_mfma_f32_32x32x16_bf16 v[64:79], v[244:247], v[20:23], v[64:79]
    v_cvt_pk_bf16_f32 v26, v84, v85
    v_cvt_pk_bf16_f32 v27, v86, v87
    v_cvt_pk_bf16_f32 v28, v88, v89
    v_cvt_pk_bf16_f32 v29, v90, v91
    v_cvt_pk_bf16_f32 v30, v92, v93
    v_cvt_pk_bf16_f32 v31, v94, v95
    s_waitcnt vmcnt(11)
    s_barrier
    s_cmp_lg_u32 s3, 0
    s_cbranch_scc1 L_w021
    buffer_load_dword v5, off, s[24:27], 0 sc1
L_w021:
    v_mfma_f32_32x32x16_bf16 v[112:127], v[248:251], v[132:135], v[112:127]
    ds_read_b64_tr_b16 v[60:61], v4 offset:6144
    ds_read_b64_tr_b16 v[62:63], v4 offset:6656
    s_waitcnt lgkmcnt(6)
    v_cndmask_b32_e64 v24, v24, v39, s[54:55]
    v_cndmask_b32_e64 v25, v25, v39, s[54:55]
    v_cndmask_b32_e64 v26, v26, v39, s[54:55]
    v_cndmask_b32_e64 v27, v27, v39, s[54:55]
    v_or_b32 v3, 98304, v45
    v_xor_b32 v4, 98336, v45
    v_mfma_f32_32x32x16_bf16 v[96:111], v[48:51], v[136:139], v[96:111]
    ds_read_b64_tr_b16 v[248:249], v3
    ds_read_b64_tr_b16 v[250:251], v3 offset:512
    s_waitcnt lgkmcnt(6)
    v_cndmask_b32_e64 v28, v28, v39, s[54:55]
    v_cndmask_b32_e64 v29, v29, v39, s[54:55]
    v_cndmask_b32_e64 v30, v30, v39, s[54:55]
    v_cndmask_b32_e64 v31, v31, v39, s[54:55]
    ds_write_b128 v38, v[24:27]
    ds_write_b128 v38, v[28:31] offset:1024
    v_max3_f32 v32, v64, v65, v66
    v_mfma_f32_32x32x16_bf16 v[112:127], v[52:55], v[136:139], v[112:127]
    ds_read_b64_tr_b16 v[48:49], v4
    ds_read_b64_tr_b16 v[50:51], v4 offset:512
    s_waitcnt lgkmcnt(8)
    v_min3_f32 v33, v64, v65, v66
    v_max3_f32 v32, v32, v67, v68
    v_min3_f32 v33, v33, v67, v68
    v_max3_f32 v32, v32, v69, v70
    v_min3_f32 v33, v33, v69, v70
    v_max3_f32 v32, v32, v71, v72
    v_mfma_f32_32x32x16_bf16 v[96:111], v[56:59], v[140:143], v[96:111]
    ds_read_b64_tr_b16 v[52:53], v3 offset:2048
    ds_read_b64_tr_b16 v[54:55], v3 offset:2560
    s_waitcnt lgkmcnt(8)
    v_min3_f32 v33, v33, v71, v72
    v_max3_f32 v32, v32, v73, v74
    v_min3_f32 v33, v33, v73, v74
    v_max3_f32 v32, v32, v75, v76
    v_min3_f32 v33, v33, v75, v76
    v_max3_f32 v32, v32, v77, v78
    v_mfma_f32_32x32x16_bf16 v[112:127], v[60:63], v[140:143], v[112:127]
    ds_read_b64_tr_b16 v[56:57], v4 offset:2048
    ds_read_b64_tr_b16 v[58:59], v4 offset:2560
    s_waitcnt lgkmcnt(8)
    v_min3_f32 v33, v33, v77, v78
    v_max_f32 v34, v32, v79
    v_min_f32 v38, v33, v79
    v_max_f32 v35, v32, v79
    v_min_f32 v39, v33, v79
    v_mul_f32 v64, s48, v64
    v_mfma_f32_32x32x16_bf16 v[96:111], v[248:251], v[144:147], v[96:111]
    ds_read_b64_tr_b16 v[60:61], v3 offset:4096
    ds_read_b64_tr_b16 v[62:63], v3 offset:4608
    s_waitcnt lgkmcnt(6)
    v_mul_f32 v65, s48, v65
    v_permlane32_swap_b32 v34, v35
    v_permlane32_swap_b32 v38, v39
    v_mul_f32 v66, s48, v66
    v_mfma_f32_32x32x16_bf16 v[112:127], v[48:51], v[144:147], v[112:127]
    ds_read_b64_tr_b16 v[248:249], v4 offset:4096
    ds_read_b64_tr_b16 v[250:251], v4 offset:4608
    s_waitcnt lgkmcnt(6)
    v_mul_f32 v67, s48, v67
    v_max_f32 v32, v34, v35
    v_min_f32 v33, v38, v39
    v_mul_f32 v32, s48, v32
    v_mul_f32 v33, s48, v33
    v_sub_f32 v80, v33, v64
    buffer_store_dwordx4 v[252:255], v7, s[20:23], s59 offen offset:1024 sc1
    v_mfma_f32_32x32x16_bf16 v[96:111], v[52:55], v[148:151], v[96:111]
    ds_read_b64_tr_b16 v[48:49], v3 offset:6144
    ds_read_b64_tr_b16 v[50:51], v3 offset:6656
    s_waitcnt lgkmcnt(6)
    v_sub_f32 v64, v64, v32
    v_sub_f32 v81, v33, v65
    v_sub_f32 v65, v65, v32
    v_sub_f32 v82, v33, v66
    v_sub_f32 v66, v66, v32
    s_waitcnt vmcnt(10)
    s_barrier
    v_mfma_f32_32x32x16_bf16 v[112:127], v[56:59], v[148:151], v[112:127]
    ds_read_b64_tr_b16 v[52:53], v4 offset:6144
    ds_read_b64_tr_b16 v[54:55], v4 offset:6656
    s_waitcnt lgkmcnt(6)
    s_add_u32 m0, s41, 81920
    s_mul_i32 s39, s32, 1792
    buffer_load_dwordx4 v43, s[16:19], s39 offen lds
    v_exp_f32 v80, v80
    v_exp_f32 v64, v64
    v_or_b32 v3, 114688, v45
    v_xor_b32 v4, 114720, v45
    v_mfma_f32_32x32x16_bf16 v[96:111], v[60:63], v[152:155], v[96:111]
    ds_read_b64_tr_b16 v[56:57], v3
    ds_read_b64_tr_b16 v[58:59], v3 offset:512
    s_waitcnt lgkmcnt(6)
    v_sub_f32 v83, v33, v67
    v_sub_f32 v67, v67, v32
    v_exp_f32 v81, v81
    v_exp_f32 v65, v65
    v_mfma_f32_32x32x16_bf16 v[112:127], v[248:251], v[152:155], v[112:127]
    ds_read_b64_tr_b16 v[60:61], v4
    ds_read_b64_tr_b16 v[62:63], v4 offset:512
    s_waitcnt lgkmcnt(6)
    s_add_u32 m0, s41, 90112
    s_mul_i32 s39, s33, 1792
    buffer_load_dwordx4 v43, s[16:19], s39 offen lds
    v_fma_f32 v84, v68, -s48, v33
    v_fma_f32 v68, v68, s48, -v32
    v_exp_f32 v82, v82
    v_exp_f32 v66, v66
    v_mfma_f32_32x32x16_bf16 v[96:111], v[48:51], v[156:159], v[96:111]
    ds_read_b64_tr_b16 v[248:249], v3 offset:2048
    ds_read_b64_tr_b16 v[250:251], v3 offset:2560
    s_waitcnt lgkmcnt(6)
    v_fma_f32 v85, v69, -s48, v33
    v_fma_f32 v69, v69, s48, -v32
    v_exp_f32 v83, v83
    v_exp_f32 v67, v67
    v_mfma_f32_32x32x16_bf16 v[112:127], v[52:55], v[156:159], v[112:127]
    ds_read_b64_tr_b16 v[48:49], v4 offset:2048
    ds_read_b64_tr_b16 v[50:51], v4 offset:2560
    s_waitcnt lgkmcnt(6)
    v_add_f32 v37, v80, v81
    v_add_f32 v36, v64, v65
    v_fma_f32 v86, v70, -s48, v33
    v_fma_f32 v70, v70, s48, -v32
    v_exp_f32 v84, v84
    v_mfma_f32_32x32x16_bf16 v[96:111], v[56:59], v[160:163], v[96:111]
    ds_read_b64_tr_b16 v[52:53], v3 offset:4096
    ds_read_b64_tr_b16 v[54:55], v3 offset:4608
    s_waitcnt lgkmcnt(6)
    v_exp_f32 v68, v68
    v_add_f32 v37, v37, v82
    v_add_f32 v36, v36, v66
    v_fma_f32 v87, v71, -s48, v33
    v_fma_f32 v71, v71, s48, -v32
    v_mfma_f32_32x32x16_bf16 v[112:127], v[60:63], v[160:163], v[112:127]
    ds_read_b64_tr_b16 v[56:57], v4 offset:4096
    ds_read_b64_tr_b16 v[58:59], v4 offset:4608
    s_waitcnt lgkmcnt(6)
    v_exp_f32 v85, v85
    v_exp_f32 v69, v69
    v_add_f32 v37, v37, v83
    v_add_f32 v36, v36, v67
    buffer_store_dwordx4 v[252:255], v7, s[20:23], s60 offen sc1
    v_mfma_f32_32x32x16_bf16 v[96:111], v[248:251], v[164:167], v[96:111]
    ds_read_b64_tr_b16 v[60:61], v3 offset:6144
    ds_read_b64_tr_b16 v[62:63], v3 offset:6656
    s_waitcnt lgkmcnt(6)
    v_fma_f32 v88, v72, -s48, v33
    v_fma_f32 v72, v72, s48, -v32
    v_exp_f32 v86, v86
    v_exp_f32 v70, v70
    s_waitcnt vmcnt(11)
    s_barrier
    v_mfma_f32_32x32x16_bf16 v[112:127], v[48:51], v[164:167], v[112:127]
    ds_read_b64_tr_b16 v[248:249], v4 offset:6144
    ds_read_b64_tr_b16 v[250:251], v4 offset:6656
    s_waitcnt lgkmcnt(6)
    s_add_u32 m0, s41, 98304
    s_mul_i32 s39, s34, 1792
    buffer_load_dwordx4 v43, s[16:19], s39 offen lds
    v_add_f32 v37, v37, v84
    v_add_f32 v36, v36, v68
    v_fma_f32 v89, v73, -s48, v33
    v_fma_f32 v73, v73, s48, -v32
    v_or_b32 v3, 131072, v45
    v_xor_b32 v4, 131104, v45
    v_mfma_f32_32x32x16_bf16 v[96:111], v[52:55], v[168:171], v[96:111]
    ds_read_b64_tr_b16 v[48:49], v3
    ds_read_b64_tr_b16 v[50:51], v3 offset:512
    s_waitcnt lgkmcnt(6)
    v_exp_f32 v87, v87
    v_exp_f32 v71, v71
    v_add_f32 v37, v37, v85
    v_add_f32 v36, v36, v69
    v_mfma_f32_32x32x16_bf16 v[112:127], v[56:59], v[168:171], v[112:127]
    ds_read_b64_tr_b16 v[52:53], v4
    ds_read_b64_tr_b16 v[54:55], v4 offset:512
    s_waitcnt lgkmcnt(6)
    s_add_u32 m0, s41, 106496
    s_mul_i32 s39, s35, 1792
    buffer_load_dwordx4 v43, s[16:19], s39 offen lds
    v_fma_f32 v90, v74, -s48, v33
    v_fma_f32 v74, v74, s48, -v32
    v_exp_f32 v88, v88
    v_exp_f32 v72, v72
    v_mfma_f32_32x32x16_bf16 v[96:111], v[60:63], v[172:175], v[96:111]
    ds_read_b64_tr_b16 v[56:57], v3 offset:2048
    ds_read_b64_tr_b16 v[58:59], v3 offset:2560
    s_waitcnt lgkmcnt(6)
    v_add_f32 v37, v37, v86
    v_add_f32 v36, v36, v70
    v_fma_f32 v91, v75, -s48, v33
    v_fma_f32 v75, v75, s48, -v32
    v_exp_f32 v89, v89
    v_mfma_f32_32x32x16_bf16 v[112:127], v[248:251], v[172:175], v[112:127]
    ds_read_b64_tr_b16 v[60:61], v4 offset:2048
    ds_read_b64_tr_b16 v[62:63], v4 offset:2560
    s_waitcnt lgkmcnt(6)
    v_exp_f32 v73, v73
    v_add_f32 v37, v37, v87
    v_add_f32 v36, v36, v71
    v_fma_f32 v92, v76, -s48, v33
    v_fma_f32 v76, v76, s48, -v32
    v_mfma_f32_32x32x16_bf16 v[96:111], v[48:51], v[176:179], v[96:111]
    ds_read_b64_tr_b16 v[248:249], v3 offset:4096
    ds_read_b64_tr_b16 v[250:251], v3 offset:4608
    s_waitcnt lgkmcnt(6)
    v_exp_f32 v90, v90
    v_exp_f32 v74, v74
    v_add_f32 v37, v37, v88
    v_add_f32 v36, v36, v72
    v_mfma_f32_32x32x16_bf16 v[112:127], v[52:55], v[176:179], v[112:127]
    ds_read_b64_tr_b16 v[48:49], v4 offset:4096
    ds_read_b64_tr_b16 v[50:51], v4 offset:4608
    s_waitcnt lgkmcnt(6)
    v_fma_f32 v93, v77, -s48, v33
    v_fma_f32 v77, v77, s48, -v32
    v_exp_f32 v91, v91
    v_exp_f32 v75, v75
    v_mfma_f32_32x32x16_bf16 v[96:111], v[56:59], v[180:183], v[96:111]
    ds_read_b64_tr_b16 v[52:53], v3 offset:6144
    ds_read_b64_tr_b16 v[54:55], v3 offset:6656
    s_waitcnt lgkmcnt(6)
    v_add_f32 v37, v37, v89
    v_add_f32 v36, v36, v73
    v_fma_f32 v94, v78, -s48, v33
    v_fma_f32 v78, v78, s48, -v32
    v_exp_f32 v92, v92
    s_cmp_lg_u32 s3, 0
    s_cbranch_scc1 L_w024
    s_waitcnt vmcnt(6)
    s_mov_b32 s73, 0
L_sp22:
    v_readfirstlane_b32 s43, v5
    s_nop 1
    s_and_b32 s43, s43, 0x1
    s_cmp_eq_u32 s43, 0x1
    s_cbranch_scc1 L_ok23
    s_add_u32 s73, s73, 1
    s_cmp_gt_u32 s73, 100000
    s_cbranch_scc1 L_ok23
    s_sleep 2
    buffer_load_dword v5, off, s[24:27], 0 sc1
    s_waitcnt vmcnt(0)
    s_branch L_sp22
L_ok23:
L_w024:
    s_waitcnt vmcnt(11)
    s_barrier
    v_mfma_f32_32x32x16_bf16 v[112:127], v[60:63], v[180:183], v[112:127]
    ds_read_b64_tr_b16 v[56:57], v4 offset:6144
    ds_read_b64_tr_b16 v[58:59], v4 offset:6656
    s_waitcnt lgkmcnt(6)
    s_add_u32 m0, s41, 114688
    s_mul_i32 s39, s36, 1792
    buffer_load_dwordx4 v43, s[16:19], s39 offen lds
    v_exp_f32 v76, v76
    v_add_f32 v37, v37, v90
    v_add_f32 v36, v36, v74
    v_or_b32 v3, 0, v45
    v_xor_b32 v4, 32, v45
    v_mfma_f32_32x32x16_bf16 v[96:111], v[248:251], v[184:187], v[96:111]
    ds_read_b64_tr_b16 v[60:61], v3
    ds_read_b64_tr_b16 v[62:63], v3 offset:512
    s_waitcnt lgkmcnt(6)
    v_fma_f32 v95, v79, -s48, v33
    v_fma_f32 v79, v79, s48, -v32
    v_exp_f32 v93, v93
    v_exp_f32 v77, v77
    v_mfma_f32_32x32x16_bf16 v[112:127], v[48:51], v[184:187], v[112:127]
    ds_read_b64_tr_b16 v[248:249], v4
    ds_read_b64_tr_b16 v[250:251], v4 offset:512
    s_waitcnt lgkmcnt(6)
    s_add_u32 m0, s41, 122880
    s_mul_i32 s39, s37, 1792
    buffer_load_dwordx4 v43, s[16:19], s39 offen lds
    v_add_f32 v37, v37, v91
    v_add_f32 v36, v36, v75
    v_exp_f32 v94, v94
    v_exp_f32 v78, v78
    v_mfma_f32_32x32x16_bf16 v[96:111], v[52:55], v[188:191], v[96:111]
    ds_read_b64_tr_b16 v[48:49], v3 offset:2048
    ds_read_b64_tr_b16 v[50:51], v3 offset:2560
    s_waitcnt lgkmcnt(6)
    v_add_f32 v38, v92, v93
    v_add_f32 v34, v76, v77
    v_exp_f32 v95, v95
    v_exp_f32 v79, v79
    v_mfma_f32_32x32x16_bf16 v[112:127], v[56:59], v[188:191], v[112:127]
    ds_read_b64_tr_b16 v[52:53], v4 offset:2048
    ds_read_b64_tr_b16 v[54:55], v4 offset:2560
    s_waitcnt lgkmcnt(6)
    v_add_f32 v38, v38, v94
    v_add_f32 v34, v34, v78
    v_add_f32 v38, v38, v95
    v_add_f32 v34, v34, v79
    v_fma_f32 v39, v38, v42, v37
    v_fma_f32 v35, v34, v42, v36
    v_mfma_f32_32x32x16_bf16 v[96:111], v[60:63], v[192:195], v[96:111]
    ds_read_b64_tr_b16 v[56:57], v3 offset:4096
    ds_read_b64_tr_b16 v[58:59], v3 offset:4608
    s_waitcnt lgkmcnt(6)
    v_fma_f32 v38, v38, v42, v37
    v_fma_f32 v34, v34, v42, v36
    s_nop 0
    v_permlane32_swap_b32 v38, v39
    v_mfma_f32_32x32x16_bf16 v[112:127], v[248:251], v[192:195], v[112:127]
    ds_read_b64_tr_b16 v[60:61], v4 offset:4096
    ds_read_b64_tr_b16 v[62:63], v4 offset:4608
    s_waitcnt lgkmcnt(6)
    v_permlane32_swap_b32 v34, v35
    v_add_f32 v37, v38, v39
    v_add_f32 v36, v34, v35
    v_rcp_f32 v36, v36
    v_mfma_f32_32x32x16_bf16 v[96:111], v[48:51], v[196:199], v[96:111]
    ds_read_b64_tr_b16 v[248:249], v3 offset:6144
    ds_read_b64_tr_b16 v[250:251], v3 offset:6656
    s_waitcnt lgkmcnt(6)
    v_rcp_f32 v37, v37
    v_mul_f32 v64, v64, v36
    v_mul_f32 v65, v65, v36
    v_mul_f32 v66, v66, v36
    v_mul_f32 v67, v67, v36
    s_waitcnt vmcnt(11)
    s_barrier
    v_mfma_f32_32x32x16_bf16 v[112:127], v[52:55], v[196:199], v[112:127]
    ds_read_b64_tr_b16 v[48:49], v4 offset:6144
    ds_read_b64_tr_b16 v[50:51], v4 offset:6656
    s_waitcnt lgkmcnt(6)
    s_add_u32 m0, s41, 131072
    s_mul_i32 s39, s38, 1792
    buffer_load_dwordx4 v43, s[16:19], s39 offen lds
    v_mul_f32 v68, v68, v36
    v_mul_f32 v69, v69, v36
    v_mul_f32 v70, v70, v36
    v_mul_f32 v71, v71, v36
    v_or_b32 v3, 16384, v45
    v_xor_b32 v4, 16416, v45
    v_mfma_f32_32x32x16_bf16 v[96:111], v[56:59], v[200:203], v[96:111]
    ds_read_b64_tr_b16 v[52:53], v3
    ds_read_b64_tr_b16 v[54:55], v3 offset:512
    s_waitcnt lgkmcnt(6)
    v_mul_f32 v72, v72, v36
    v_mul_f32 v73, v73, v36
    v_mul_f32 v74, v74, v36
    v_mul_f32 v75, v75, v36
    v_mul_f32 v76, v76, v36
    v_mul_f32 v77, v77, v36
    v_mfma_f32_32x32x16_bf16 v[112:127], v[60:63], v[200:203], v[112:127]
    ds_read_b64_tr_b16 v[56:57], v4
    ds_read_b64_tr_b16 v[58:59], v4 offset:512
    s_waitcnt lgkmcnt(6)
    s_cmp_gt_u32 s3, 1
    s_cbranch_scc1 L_tw40
    s_cmp_eq_u32 s3, 1
    s_cbranch_scc1 L_tw39
    s_mul_i32 s43, s2, 6272
    v_min_u32 v0, 48, v1
    v_lshlrev_b32 v0, 7, v0
    buffer_load_dword v0, v0, s[88:91], s43 offen
    s_branch L_tw40
L_tw39:
    s_mul_i32 s43, s2, 1664
    s_waitcnt vmcnt(0)
    v_min_u32 v0, 12, v1
    s_waitcnt vmcnt(0)
    v_lshlrev_b32 v0, 7, v0
    s_waitcnt vmcnt(0)
    buffer_load_dword v0, v0, s[92:95], s43 offen
L_tw40:
    v_mul_f32 v78, v78, v36
    v_mul_f32 v79, v79, v36
    v_mul_f32 v80, v80, v37
    v_mul_f32 v81, v81, v37
    v_cvt_pk_bf16_f32 v16, v64, v65
    v_mul_f32 v82, v82, v37
    v_mfma_f32_32x32x16_bf16 v[96:111], v[248:251], v[204:207], v[96:111]
    ds_read_b64_tr_b16 v[60:61], v3 offset:2048
    ds_read_b64_tr_b16 v[62:63], v3 offset:2560
    s_waitcnt lgkmcnt(6)
    v_mul_f32 v83, v83, v37
    v_cvt_pk_bf16_f32 v17, v66, v67
    v_mul_f32 v84, v84, v37
    v_mul_f32 v85, v85, v37
    v_cvt_pk_bf16_f32 v18, v68, v69
    v_mul_f32 v86, v86, v37
    v_mfma_f32_32x32x16_bf16 v[112:127], v[48:51], v[204:207], v[112:127]
    ds_read_b64_tr_b16 v[248:249], v4 offset:2048
    ds_read_b64_tr_b16 v[250:251], v4 offset:2560
    s_waitcnt lgkmcnt(6)
    v_mul_f32 v87, v87, v37
    v_cvt_pk_bf16_f32 v19, v70, v71
    v_mul_f32 v88, v88, v37
    v_mul_f32 v89, v89, v37
    v_cvt_pk_bf16_f32 v20, v72, v73
    v_mul_f32 v90, v90, v37
    v_mfma_f32_32x32x16_bf16 v[96:111], v[52:55], v[208:211], v[96:111]
    ds_read_b64_tr_b16 v[48:49], v3 offset:4096
    ds_read_b64_tr_b16 v[50:51], v3 offset:4608
    s_waitcnt lgkmcnt(6)
    v_mul_f32 v91, v91, v37
    v_cvt_pk_bf16_f32 v21, v74, v75
    v_mul_f32 v92, v92, v37
    v_mul_f32 v93, v93, v37
    v_cvt_pk_bf16_f32 v22, v76, v77
    v_mul_f32 v94, v94, v37
    v_mfma_f32_32x32x16_bf16 v[112:127], v[56:59], v[208:211], v[112:127]
    ds_read_b64_tr_b16 v[52:53], v4 offset:4096
    ds_read_b64_tr_b16 v[54:55], v4 offset:4608
    s_waitcnt lgkmcnt(6)
    v_mul_f32 v95, v95, v37
    v_cvt_pk_bf16_f32 v23, v78, v79
    v_cvt_pk_bf16_f32 v24, v80, v81
    v_cvt_pk_bf16_f32 v25, v82, v83
    v_cvt_pk_bf16_f32 v26, v84, v85
    v_cvt_pk_bf16_f32 v27, v86, v87
    v_mfma_f32_32x32x16_bf16 v[96:111], v[60:63], v[212:215], v[96:111]
    ds_read_b64_tr_b16 v[56:57], v3 offset:6144
    ds_read_b64_tr_b16 v[58:59], v3 offset:6656
    s_waitcnt lgkmcnt(6)
    v_cvt_pk_bf16_f32 v28, v88, v89
    v_cvt_pk_bf16_f32 v29, v90, v91
    v_cvt_pk_bf16_f32 v30, v92, v93
    v_cvt_pk_bf16_f32 v31, v94, v95
    v_xor_b32 v34, 0, v15
    ds_write_b64 v34, v[16:17]
    s_waitcnt vmcnt(5)
    s_barrier
    s_cmp_lg_u32 s3, 0
    s_cbranch_scc1 L_w020
    s_mov_b64 exec, 1
    v_mov_b32 v255, 256
    buffer_atomic_add v255, off, s[20:23], s80 sc1
    s_mov_b64 exec, -1
L_w020:
    v_mfma_f32_32x32x16_bf16 v[112:127], v[248:251], v[212:215], v[112:127]
    ds_read_b64_tr_b16 v[60:61], v4 offset:6144
    ds_read_b64_tr_b16 v[62:63], v4 offset:6656
    s_waitcnt lgkmcnt(7)
    s_mul_i32 s39, s58, 286720
    s_mul_i32 m0, s84, 401408
    s_add_u32 s39, s39, m0
    s_add_u32 m0, s40, 0
    s_nop 0
    buffer_load_dwordx4 v8, s[88:91], s39 offen lds
    v_xor_b32 v35, 16, v15
    ds_write_b64 v35, v[18:19]
    v_xor_b32 v34, 32, v15
    ds_write_b64 v34, v[20:21]
    v_xor_b32 v35, 48, v15
    v_or_b32 v3, 32768, v45
    v_xor_b32 v4, 32800, v45
    v_mfma_f32_32x32x16_bf16 v[96:111], v[48:51], v[216:219], v[96:111]
    ds_read_b64_tr_b16 v[248:249], v3
    ds_read_b64_tr_b16 v[250:251], v3 offset:512
    s_waitcnt lgkmcnt(9)
    ds_write_b64 v35, v[22:23]
    v_xor_b32 v34, 64, v15
    ds_write_b64 v34, v[24:25]
    v_xor_b32 v35, 80, v15
    ds_write_b64 v35, v[26:27]
    v_xor_b32 v34, 96, v15
    ds_write_b64 v34, v[28:29]
    v_xor_b32 v35, 112, v15
    v_mfma_f32_32x32x16_bf16 v[112:127], v[52:55], v[216:219], v[112:127]
    ds_read_b64_tr_b16 v[48:49], v4
    ds_read_b64_tr_b16 v[50:51], v4 offset:512
    s_waitcnt lgkmcnt(13)
    buffer_load_dwordx4 v9, s[88:91], s39 offen offset:1024 lds
    ds_write_b64 v35, v[30:31]
    v_xor_b32 v32, 16, v40
    v_lshlrev_b32 v33, 4, v1
    v_mfma_f32_32x32x16_bf16 v[96:111], v[56:59], v[220:223], v[96:111]
    ds_read_b64_tr_b16 v[52:53], v3 offset:2048
    s_waitcnt lgkmcnt(14)
    ds_read_b64_tr_b16 v[54:55], v3 offset:2560
    s_waitcnt lgkmcnt(13)
    v_mfma_f32_32x32x16_bf16 v[112:127], v[60:63], v[220:223], v[112:127]
    ds_read_b64_tr_b16 v[56:57], v4 offset:2048
    ds_read_b64_tr_b16 v[58:59], v4 offset:2560
    s_waitcnt lgkmcnt(11)
    v_mfma_f32_32x32x16_bf16 v[96:111], v[248:251], v[224:227], v[96:111]
    ds_read_b64_tr_b16 v[60:61], v3 offset:4096
    ds_read_b64_tr_b16 v[62:63], v3 offset:4608
    s_waitcnt lgkmcnt(7)
    v_mfma_f32_32x32x16_bf16 v[112:127], v[48:51], v[224:227], v[112:127]
    ds_read_b64_tr_b16 v[248:249], v4 offset:4096
    ds_read_b64_tr_b16 v[250:251], v4 offset:4608
    s_waitcnt lgkmcnt(6)
    v_mfma_f32_32x32x16_bf16 v[96:111], v[52:55], v[228:231], v[96:111]
    ds_read_b64_tr_b16 v[48:49], v3 offset:6144
    ds_read_b64_tr_b16 v[50:51], v3 offset:6656
    s_waitcnt lgkmcnt(6)
    s_waitcnt lgkmcnt(0)
    s_barrier
    v_mfma_f32_32x32x16_bf16 v[112:127], v[56:59], v[228:231], v[112:127]
    ds_read_b64_tr_b16 v[52:53], v4 offset:6144
    ds_read_b64_tr_b16 v[54:55], v4 offset:6656
    s_mul_i32 s39, s58, 286720
    s_mul_i32 m0, s85, 401408
    s_add_u32 s39, s39, m0
    s_add_u32 m0, s40, 16384
    s_nop 0
    buffer_load_dwordx4 v8, s[88:91], s39 offen lds
    ds_read_b64_tr_b16 v[16:17], v40
    ds_read_b64_tr_b16 v[18:19], v32 offset:1024
    ds_read_b128 v[24:27], v41
    ds_read_b64_tr_b16 v[20:21], v40 offset:2048
    ds_read_b64_tr_b16 v[22:23], v32 offset:3072
    ds_read_b128 v[28:31], v41 offset:1024
    v_or_b32 v3, 81920, v46
    v_mfma_f32_32x32x16_bf16 v[96:111], v[60:63], v[232:235], v[96:111]
    ds_read_b64_tr_b16 v[56:57], v3
    ds_read_b64_tr_b16 v[58:59], v3 offset:256
    s_waitcnt lgkmcnt(5)
    v_mfma_f32_32x32x16_bf16 v[64:79], v[16:19], v[24:27], 0
    ds_read_b64_tr_b16 v[16:17], v40 offset:4096
    ds_read_b64_tr_b16 v[18:19], v32 offset:5120
    ds_read_b128 v[24:27], v41 offset:2048
    v_mfma_f32_32x32x16_bf16 v[112:127], v[248:251], v[232:235], v[112:127]
    ds_read_b64_tr_b16 v[60:61], v3 offset:1024
    ds_read_b64_tr_b16 v[62:63], v3 offset:1280
    buffer_load_dwordx4 v9, s[88:91], s39 offen offset:1024 lds
    s_waitcnt lgkmcnt(7)
    v_mfma_f32_32x32x16_bf16 v[64:79], v[20:23], v[28:31], v[64:79]
    ds_read_b64_tr_b16 v[20:21], v40 offset:6144
    ds_read_b64_tr_b16 v[22:23], v32 offset:7168
    ds_read_b128 v[28:31], v41 offset:3072
    v_mfma_f32_32x32x16_bf16 v[96:111], v[48:51], v[236:239], v[96:111]
    ds_read_b64_tr_b16 v[248:249], v3 offset:2048
    ds_read_b64_tr_b16 v[250:251], v3 offset:2304
    s_waitcnt lgkmcnt(7)
    v_mfma_f32_32x32x16_bf16 v[64:79], v[16:19], v[24:27], v[64:79]
    ds_read_b64_tr_b16 v[16:17], v40 offset:8192
    ds_read_b64_tr_b16 v[18:19], v32 offset:9216
    ds_read_b128 v[24:27], v41 offset:4096
    v_mfma_f32_32x32x16_bf16 v[112:127], v[52:55], v[236:239], v[112:127]
    ds_read_b64_tr_b16 v[48:49], v3 offset:3072
    ds_read_b64_tr_b16 v[50:51], v3 offset:3328
    s_waitcnt lgkmcnt(7)
    v_mfma_f32_32x32x16_bf16 v[64:79], v[20:23], v[28:31], v[64:79]
    ds_read_b64_tr_b16 v[20:21], v40 offset:10240
    ds_read_b64_tr_b16 v[22:23], v32 offset:11264
    ds_read_b128 v[28:31], v41 offset:5120
    v_mfma_f32_32x32x16_bf16 v[80:95], v[56:59], v[128:131], 0
    ds_read_b64_tr_b16 v[52:53], v3 offset:8192
    ds_read_b64_tr_b16 v[54:55], v3 offset:8448
    s_waitcnt lgkmcnt(7)
    v_mfma_f32_32x32x16_bf16 v[64:79], v[16:19], v[24:27], v[64:79]
    ds_read_b64_tr_b16 v[16:17], v40 offset:12288
    ds_read_b64_tr_b16 v[18:19], v32 offset:13312
    ds_read_b128 v[24:27], v41 offset:6144
    v_mfma_f32_32x32x16_bf16 v[80:95], v[60:63], v[132:135], v[80:95]
    ds_read_b64_tr_b16 v[56:57], v3 offset:9216
    ds_read_b64_tr_b16 v[58:59], v3 offset:9472
    s_waitcnt lgkmcnt(7)
    v_mfma_f32_32x32x16_bf16 v[64:79], v[20:23], v[28:31], v[64:79]
    ds_read_b64_tr_b16 v[20:21], v40 offset:14336
    ds_read_b64_tr_b16 v[22:23], v32 offset:15360
    ds_read_b128 v[28:31], v41 offset:7168
    v_mfma_f32_32x32x16_bf16 v[80:95], v[248:251], v[136:139], v[80:95]
    ds_read_b64_tr_b16 v[60:61], v3 offset:10240
    ds_read_b64_tr_b16 v[62:63], v3 offset:10496
    s_waitcnt lgkmcnt(7)
    v_mfma_f32_32x32x16_bf16 v[64:79], v[16:19], v[24:27], v[64:79]
    s_waitcnt vmcnt(7)
    s_barrier
    v_mfma_f32_32x32x16_bf16 v[80:95], v[48:51], v[140:143], v[80:95]
    ds_read_b64_tr_b16 v[248:249], v3 offset:11264
    ds_read_b64_tr_b16 v[250:251], v3 offset:11520
    s_mul_i32 s39, s58, 286720
    s_mul_i32 m0, s86, 401408
    s_add_u32 s39, s39, m0
    s_add_u32 m0, s40, 32768
    s_nop 0
    buffer_load_dwordx4 v8, s[88:91], s39 offen lds
    s_waitcnt lgkmcnt(4)
    v_mfma_f32_32x32x16_bf16 v[64:79], v[20:23], v[28:31], v[64:79]
    v_or_b32 v3, 98304, v46
    v_mfma_f32_32x32x16_bf16 v[80:95], v[52:55], v[144:147], v[80:95]
    ds_read_b64_tr_b16 v[48:49], v3
    ds_read_b64_tr_b16 v[50:51], v3 offset:256
    v_mul_f32 v16, v96, v96
    v_mul_f32 v17, v97, v97
    v_mul_f32 v18, v98, v98
    v_mul_f32 v19, v99, v99
    v_mul_f32 v20, v100, v100
    v_mul_f32 v21, v101, v101
    v_mfma_f32_32x32x16_bf16 v[80:95], v[56:59], v[148:151], v[80:95]
    ds_read_b64_tr_b16 v[52:53], v3 offset:1024
    ds_read_b64_tr_b16 v[54:55], v3 offset:1280
    s_waitcnt lgkmcnt(6)
    buffer_load_dwordx4 v9, s[88:91], s39 offen offset:1024 lds
    v_mul_f32 v22, v102, v102
    v_mul_f32 v23, v103, v103
    v_fma_f32 v16, v16, s49, v47
    v_mul_f32 v104, v96, v104
    v_fma_f32 v17, v17, s49, v47
    v_mul_f32 v105, v97, v105
    s_bitcmp1_b32 s3, 1
    s_cbranch_scc1 L_kv33
    buffer_store_dwordx4 v[64:67], v33, s[20:23], s50 offen sc1
    buffer_store_dwordx4 v[68:71], v33, s[20:23], s50 offen offset:1024 sc1
    buffer_store_dwordx4 v[72:75], v33, s[20:23], s50 offen offset:2048 sc1
    buffer_store_dwordx4 v[76:79], v33, s[20:23], s50 offen offset:3072 sc1
L_kv33:
    v_mfma_f32_32x32x16_bf16 v[80:95], v[60:63], v[152:155], v[80:95]
    ds_read_b64_tr_b16 v[56:57], v3 offset:2048
    ds_read_b64_tr_b16 v[58:59], v3 offset:2304
    s_waitcnt lgkmcnt(6)
    v_fma_f32 v18, v18, s49, v47
    v_mul_f32 v106, v98, v106
    v_fma_f32 v19, v19, s49, v47
    v_mul_f32 v107, v99, v107
    v_fma_f32 v20, v20, s49, v47
    v_mul_f32 v108, v100, v108
    v_mfma_f32_32x32x16_bf16 v[80:95], v[248:251], v[156:159], v[80:95]
    ds_read_b64_tr_b16 v[60:61], v3 offset:3072
    ds_read_b64_tr_b16 v[62:63], v3 offset:3328
    s_waitcnt lgkmcnt(6)
    v_fma_f32 v21, v21, s49, v47
    v_mul_f32 v109, v101, v109
    v_fma_f32 v22, v22, s49, v47
    v_mul_f32 v110, v102, v110
    v_fma_f32 v23, v23, s49, v47
    v_mul_f32 v111, v103, v111
    v_mfma_f32_32x32x16_bf16 v[80:95], v[48:51], v[160:163], v[80:95]
    ds_read_b64_tr_b16 v[248:249], v3 offset:8192
    ds_read_b64_tr_b16 v[250:251], v3 offset:8448
    s_waitcnt lgkmcnt(6)
    v_mul_f32 v16, v16, v96
    v_mul_f32 v17, v17, v97
    v_mul_f32 v18, v18, v98
    v_mul_f32 v19, v19, v99
    v_mul_f32 v20, v20, v100
    v_mul_f32 v21, v21, v101
    v_mfma_f32_32x32x16_bf16 v[80:95], v[52:55], v[164:167], v[80:95]
    ds_read_b64_tr_b16 v[48:49], v3 offset:9216
    ds_read_b64_tr_b16 v[50:51], v3 offset:9472
    s_waitcnt lgkmcnt(6)
    v_mul_f32 v22, v22, v102
    v_mul_f32 v23, v23, v103
    v_exp_f32 v16, v16
    v_exp_f32 v17, v17
    v_mfma_f32_32x32x16_bf16 v[80:95], v[56:59], v[168:171], v[80:95]
    ds_read_b64_tr_b16 v[52:53], v3 offset:10240
    ds_read_b64_tr_b16 v[54:55], v3 offset:10496
    s_waitcnt lgkmcnt(6)
    v_exp_f32 v18, v18
    v_add_f32 v16, 1.0, v16
    v_exp_f32 v19, v19
    v_add_f32 v17, 1.0, v17
    s_waitcnt vmcnt(7)
    s_barrier
    s_cmp_lg_u32 s3, 0
    s_cbranch_scc1 L_w025
    buffer_load_dword v252, off, s[20:23], s81 sc1
L_w025:
    v_mfma_f32_32x32x16_bf16 v[80:95], v[60:63], v[172:175], v[80:95]
    ds_read_b64_tr_b16 v[56:57], v3 offset:11264
    ds_read_b64_tr_b16 v[58:59], v3 offset:11520
    s_waitcnt lgkmcnt(6)
    s_mul_i32 s39, s58, 286720
    s_mul_i32 m0, s87, 401408
    s_add_u32 s39, s39, m0
    s_add_u32 m0, s40, 81920
    s_nop 0
    buffer_load_dwordx4 v8, s[88:91], s39 offen lds
    v_exp_f32 v20, v20
    v_add_f32 v18, 1.0, v18
    v_exp_f32 v21, v21
    v_or_b32 v3, 114688, v46
    v_mfma_f32_32x32x16_bf16 v[80:95], v[248:251], v[176:179], v[80:95]
    ds_read_b64_tr_b16 v[60:61], v3
    ds_read_b64_tr_b16 v[62:63], v3 offset:256
    s_waitcnt lgkmcnt(6)
    v_add_f32 v19, 1.0, v19
    v_exp_f32 v22, v22
    v_add_f32 v20, 1.0, v20
    v_exp_f32 v23, v23
    v_mfma_f32_32x32x16_bf16 v[80:95], v[48:51], v[180:183], v[80:95]
    ds_read_b64_tr_b16 v[248:249], v3 offset:1024
    ds_read_b64_tr_b16 v[250:251], v3 offset:1280
    s_waitcnt lgkmcnt(6)
    buffer_load_dwordx4 v9, s[88:91], s39 offen offset:1024 lds
    v_add_f32 v21, 1.0, v21
    v_add_f32 v22, 1.0, v22
    v_add_f32 v23, 1.0, v23
    v_rcp_f32 v16, v16
    v_mfma_f32_32x32x16_bf16 v[80:95], v[52:55], v[184:187], v[80:95]
    ds_read_b64_tr_b16 v[48:49], v3 offset:2048
    ds_read_b64_tr_b16 v[50:51], v3 offset:2304
    s_waitcnt lgkmcnt(6)
    v_rcp_f32 v17, v17
    v_rcp_f32 v18, v18
    v_mul_f32 v104, v104, v16
    v_mfma_f32_32x32x16_bf16 v[80:95], v[56:59], v[188:191], v[80:95]
    ds_read_b64_tr_b16 v[52:53], v3 offset:3072
    ds_read_b64_tr_b16 v[54:55], v3 offset:3328
    s_waitcnt lgkmcnt(6)
    s_mul_i32 s39, s58, 286720
    s_mul_i32 m0, s84, 401408
    s_add_u32 s39, s39, m0
    s_add_u32 s39, s39, 57344
    s_add_u32 m0, s40, 49152
    s_nop 0
    buffer_load_dwordx4 v8, s[88:91], s39 offen lds
    v_rcp_f32 v19, v19
    v_mul_f32 v105, v105, v17
    v_rcp_f32 v20, v20
    v_mul_f32 v106, v106, v18
    v_mfma_f32_32x32x16_bf16 v[80:95], v[60:63], v[192:195], v[80:95]
    ds_read_b64_tr_b16 v[56:57], v3 offset:8192
    ds_read_b64_tr_b16 v[58:59], v3 offset:8448
    s_waitcnt lgkmcnt(6)
    v_rcp_f32 v21, v21
    v_mul_f32 v107, v107, v19
    v_rcp_f32 v22, v22
    v_mul_f32 v108, v108, v20
    v_mfma_f32_32x32x16_bf16 v[80:95], v[248:251], v[196:199], v[80:95]
    ds_read_b64_tr_b16 v[60:61], v3 offset:9216
    ds_read_b64_tr_b16 v[62:63], v3 offset:9472
    s_waitcnt lgkmcnt(6)
    buffer_load_dwordx4 v9, s[88:91], s39 offen offset:1024 lds
    v_rcp_f32 v23, v23
    v_mul_f32 v109, v109, v21
    v_mul_f32 v110, v110, v22
    v_mul_f32 v111, v111, v23
    v_cvt_pk_bf16_f32 v96, v104, v105
    v_mfma_f32_32x32x16_bf16 v[80:95], v[48:51], v[200:203], v[80:95]
    ds_read_b64_tr_b16 v[248:249], v3 offset:10240
    ds_read_b64_tr_b16 v[250:251], v3 offset:10496
    s_waitcnt lgkmcnt(6)
    v_cvt_pk_bf16_f32 v97, v106, v107
    v_cvt_pk_bf16_f32 v98, v108, v109
    v_cvt_pk_bf16_f32 v99, v110, v111
    buffer_store_dwordx4 v[96:99], v7, s[20:23], s59 offen sc1
    v_mul_f32 v16, v112, v112
    v_mul_f32 v17, v113, v113
    s_cmp_lg_u32 s3, 0
    s_cbranch_scc1 L_w028
    s_waitcnt vmcnt(5)
    s_mov_b32 s73, 0
L_sp26:
    v_readfirstlane_b32 s43, v252
    s_nop 1
    s_and_b32 s43, s43, 0xff
    s_cmp_eq_u32 s43, 0x8
    s_cbranch_scc1 L_ok27
    s_add_u32 s73, s73, 1
    s_cmp_gt_u32 s73, 100000
    s_cbranch_scc1 L_ok27
    s_sleep 2
    buffer_load_dword v252, off, s[20:23], s81 sc1
    s_waitcnt vmcnt(0)
    s_branch L_sp26
L_ok27:
L_w028:
    s_waitcnt vmcnt(5)
    s_barrier
    s_cmp_lg_u32 s3, 0
    s_cbranch_scc1 L_w034
    s_mov_b64 exec, 1
    v_mov_b32 v255, 1
    buffer_atomic_add v255, off, s[20:23], s82 sc1
    s_mov_b64 exec, -1
L_w034:
    v_mfma_f32_32x32x16_bf16 v[80:95], v[52:55], v[204:207], v[80:95]
    ds_read_b64_tr_b16 v[48:49], v3 offset:11264
    ds_read_b64_tr_b16 v[50:51], v3 offset:11520
    s_waitcnt lgkmcnt(6)
    s_mul_i32 s69, s70, 20480
    s_mul_i32 s74, s84, 28672
    s_add_u32 s69, s69, s74
    s_add_u32 s69, s69, 32768
    buffer_load_dwordx4 v[128:131], v6, s[20:23], s69 offen sc1
    v_mul_f32 v18, v114, v114
    v_mul_f32 v19, v115, v115
    v_mul_f32 v20, v116, v116
    v_mul_f32 v21, v117, v117
    v_mul_f32 v22, v118, v118
    v_or_b32 v3, 131072, v46
    v_mfma_f32_32x32x16_bf16 v[80:95], v[56:59], v[208:211], v[80:95]
    ds_read_b64_tr_b16 v[52:53], v3
    ds_read_b64_tr_b16 v[54:55], v3 offset:256
    s_waitcnt lgkmcnt(6)
    v_mul_f32 v23, v119, v119
    v_fma_f32 v16, v16, s49, v47
    v_mul_f32 v120, v112, v120
    v_fma_f32 v17, v17, s49, v47
    v_mul_f32 v121, v113, v121
    v_fma_f32 v18, v18, s49, v47
    v_mfma_f32_32x32x16_bf16 v[80:95], v[60:63], v[212:215], v[80:95]
    ds_read_b64_tr_b16 v[56:57], v3 offset:1024
    ds_read_b64_tr_b16 v[58:59], v3 offset:1280
    s_waitcnt lgkmcnt(6)
    buffer_load_dwordx4 v[132:135], v6, s[20:23], s69 offen offset:1024 sc1
    v_mul_f32 v122, v114, v122
    v_fma_f32 v19, v19, s49, v47
    v_mul_f32 v123, v115, v123
    v_fma_f32 v20, v20, s49, v47
    v_mul_f32 v124, v116, v124
    v_fma_f32 v21, v21, s49, v47
    v_mfma_f32_32x32x16_bf16 v[80:95], v[248:251], v[216:219], v[80:95]
    ds_read_b64_tr_b16 v[60:61], v3 offset:2048
    ds_read_b64_tr_b16 v[62:63], v3 offset:2304
    s_waitcnt lgkmcnt(6)
    v_mul_f32 v125, v117, v125
    v_fma_f32 v22, v22, s49, v47
    v_mul_f32 v126, v118, v126
    v_fma_f32 v23, v23, s49, v47
    v_mul_f32 v127, v119, v127
    v_mul_f32 v16, v16, v112
    v_mfma_f32_32x32x16_bf16 v[80:95], v[48:51], v[220:223], v[80:95]
    ds_read_b64_tr_b16 v[248:249], v3 offset:3072
    ds_read_b64_tr_b16 v[250:251], v3 offset:3328
    s_waitcnt lgkmcnt(6)
    s_mul_i32 s69, s70, 20480
    s_mul_i32 s74, s85, 28672
    s_add_u32 s69, s69, s74
    s_add_u32 s69, s69, 32768
    buffer_load_dwordx4 v[136:139], v6, s[20:23], s69 offen sc1
    v_mul_f32 v17, v17, v113
    v_mul_f32 v18, v18, v114
    v_mul_f32 v19, v19, v115
    v_mul_f32 v20, v20, v116
    v_or_b32 v3, 0, v14
    v_xor_b32 v4, 64, v14
    s_barrier
    v_mfma_f32_32x32x16_bf16 v[80:95], v[52:55], v[224:227], v[80:95]
    ds_read_b64_tr_b16 v[48:49], v3
    ds_read_b64_tr_b16 v[50:51], v3 offset:1024
    s_waitcnt lgkmcnt(6)
    v_mul_f32 v21, v21, v117
    v_mul_f32 v22, v22, v118
    v_mul_f32 v23, v23, v119
    v_exp_f32 v16, v16
    v_mfma_f32_32x32x16_bf16 v[80:95], v[56:59], v[228:231], v[80:95]
    ds_read_b64_tr_b16 v[52:53], v4
    ds_read_b64_tr_b16 v[54:55], v4 offset:1024
    s_waitcnt lgkmcnt(6)
    buffer_load_dwordx4 v[140:143], v6, s[20:23], s69 offen offset:1024 sc1
    v_exp_f32 v17, v17
    v_exp_f32 v18, v18
    v_add_f32 v16, 1.0, v16
    v_mfma_f32_32x32x16_bf16 v[80:95], v[60:63], v[232:235], v[80:95]
    ds_read_b64_tr_b16 v[56:57], v3 offset:2048
    ds_read_b64_tr_b16 v[58:59], v3 offset:3072
    s_waitcnt lgkmcnt(6)
    v_exp_f32 v19, v19
    v_add_f32 v17, 1.0, v17
    v_exp_f32 v20, v20
    v_add_f32 v18, 1.0, v18
    v_mfma_f32_32x32x16_bf16 v[80:95], v[248:251], v[236:239], v[80:95]
    ds_read_b64_tr_b16 v[60:61], v4 offset:2048
    ds_read_b64_tr_b16 v[62:63], v4 offset:3072
    s_waitcnt lgkmcnt(6)
    s_mul_i32 s69, s70, 20480
    s_mul_i32 s74, s86, 28672
    s_add_u32 s69, s69, s74
    s_add_u32 s69, s69, 32768
    buffer_load_dwordx4 v[144:147], v6, s[20:23], s69 offen sc1
    v_exp_f32 v21, v21
    v_add_f32 v19, 1.0, v19
    v_or_b32 v3, 16384, v14
    v_xor_b32 v4, 16448, v14
    s_barrier
    s_waitcnt vmcnt(4)
    v_mfma_f32_32x32x16_bf16 v[160:175], v[48:51], v[128:131], 0
    ds_read_b64_tr_b16 v[248:249], v3
    ds_read_b64_tr_b16 v[250:251], v3 offset:1024
    s_waitcnt lgkmcnt(6)
    buffer_load_dwordx4 v[148:151], v6, s[20:23], s69 offen offset:1024 sc1
    v_exp_f32 v22, v22
    v_add_f32 v20, 1.0, v20
    v_exp_f32 v23, v23
    v_add_f32 v21, 1.0, v21
    v_add_f32 v22, 1.0, v22
    v_add_f32 v23, 1.0, v23
    v_rcp_f32 v16, v16
    v_rcp_f32 v17, v17
    v_rcp_f32 v18, v18
    v_mul_f32 v120, v120, v16
    s_mul_i32 s69, s70, 20480
    s_mul_i32 s74, s87, 28672
    s_add_u32 s69, s69, s74
    s_add_u32 s69, s69, 32768
    buffer_load_dwordx4 v[152:155], v6, s[20:23], s69 offen sc1
    v_rcp_f32 v19, v19
    v_mul_f32 v121, v121, v17
    v_rcp_f32 v20, v20
    v_mul_f32 v122, v122, v18
    v_rcp_f32 v21, v21
    v_mul_f32 v123, v123, v19
    v_rcp_f32 v22, v22
    v_mul_f32 v124, v124, v20
    buffer_load_dwordx4 v[156:159], v6, s[20:23], s69 offen offset:1024 sc1
    v_rcp_f32 v23, v23
    v_mul_f32 v125, v125, v21
    v_mul_f32 v126, v126, v22
    v_mul_f32 v127, v127, v23
    v_cvt_pk_bf16_f32 v112, v120, v121
    v_cvt_pk_bf16_f32 v113, v122, v123
    v_cvt_pk_bf16_f32 v114, v124, v125
    v_cvt_pk_bf16_f32 v115, v126, v127
    buffer_store_dwordx4 v[112:115], v7, s[20:23], s59 offen offset:1024 sc1
    v_mul_f32 v16, v80, v80
    v_mul_f32 v17, v81, v81
    v_mul_f32 v18, v82, v82
    s_mul_i32 s39, s58, 286720
    s_mul_i32 m0, s85, 401408
    s_add_u32 s39, s39, m0
    s_add_u32 s39, s39, 57344
    s_add_u32 m0, s40, 65536
    s_nop 0
    buffer_load_dwordx4 v8, s[88:91], s39 offen lds
    v_mul_f32 v19, v83, v83
    v_mul_f32 v20, v84, v84
    v_mul_f32 v21, v85, v85
    v_mul_f32 v22, v86, v86
    v_mul_f32 v23, v87, v87
    v_fma_f32 v16, v16, s49, v47
    v_mul_f32 v88, v80, v88
    v_fma_f32 v17, v17, s49, v47
    v_mul_f32 v89, v81, v89
    v_fma_f32 v18, v18, s49, v47
    v_mul_f32 v90, v82, v90
    v_fma_f32 v19, v19, s49, v47
    buffer_load_dwordx4 v9, s[88:91], s39 offen offset:1024 lds
    v_mul_f32 v91, v83, v91
    v_fma_f32 v20, v20, s49, v47
    v_mul_f32 v92, v84, v92
    v_fma_f32 v21, v21, s49, v47
    v_mul_f32 v93, v85, v93
    v_fma_f32 v22, v22, s49, v47
    v_mul_f32 v94, v86, v94
    v_fma_f32 v23, v23, s49, v47
    v_mfma_f32_32x32x16_bf16 v[176:191], v[52:55], v[128:131], 0
    ds_read_b64_tr_b16 v[48:49], v4
    ds_read_b64_tr_b16 v[50:51], v4 offset:1024
    s_waitcnt lgkmcnt(6)
    s_mul_i32 s39, s58, 286720
    s_mul_i32 m0, s86, 401408
    s_add_u32 s39, s39, m0
    s_add_u32 s39, s39, 57344
    s_add_u32 m0, s40, 98304
    s_nop 0
    buffer_load_dwordx4 v8, s[88:91], s39 offen lds
    v_mul_f32 v95, v87, v95
    v_mul_f32 v16, v16, v80
    v_mul_f32 v17, v17, v81
    v_mul_f32 v18, v18, v82
    v_mul_f32 v19, v19, v83
    v_mul_f32 v20, v20, v84
    v_mul_f32 v21, v21, v85
    v_mul_f32 v22, v22, v86
    v_mul_f32 v23, v23, v87
    v_exp_f32 v16, v16
    v_exp_f32 v17, v17
    v_exp_f32 v18, v18
    v_add_f32 v16, 1.0, v16
    buffer_load_dwordx4 v9, s[88:91], s39 offen offset:1024 lds
    v_exp_f32 v19, v19
    v_add_f32 v17, 1.0, v17
    v_exp_f32 v20, v20
    v_add_f32 v18, 1.0, v18
    v_exp_f32 v21, v21
    v_add_f32 v19, 1.0, v19
    v_exp_f32 v22, v22
    v_add_f32 v20, 1.0, v20
    s_mul_i32 s39, s58, 286720
    s_mul_i32 m0, s87, 401408
    s_add_u32 s39, s39, m0
    s_add_u32 s39, s39, 57344
    s_add_u32 m0, s40, 114688
    s_nop 0
    buffer_load_dwordx4 v8, s[88:91], s39 offen lds
    v_exp_f32 v23, v23
    v_add_f32 v21, 1.0, v21
    v_add_f32 v22, 1.0, v22
    v_add_f32 v23, 1.0, v23
    v_rcp_f32 v16, v16
    v_rcp_f32 v17, v17
    v_rcp_f32 v18, v18
    v_mul_f32 v88, v88, v16
    buffer_load_dwordx4 v9, s[88:91], s39 offen offset:1024 lds
    v_rcp_f32 v19, v19
    v_mul_f32 v89, v89, v17
    v_rcp_f32 v20, v20
    v_mul_f32 v90, v90, v18
    v_rcp_f32 v21, v21
    v_mul_f32 v91, v91, v19
    v_rcp_f32 v22, v22
    v_mul_f32 v92, v92, v20
    s_mul_i32 s39, s58, 114688
    s_mul_i32 m0, s84, 401408
    s_add_u32 s39, s39, m0
    s_add_u32 s39, s39, 114688
    s_add_u32 m0, s40, 131072
    s_nop 0
    buffer_load_dwordx4 v8, s[88:91], s39 offen lds
    v_rcp_f32 v23, v23
    v_mul_f32 v93, v93, v21
    v_mul_f32 v94, v94, v22
    v_mul_f32 v95, v95, v23
    v_cvt_pk_bf16_f32 v80, v88, v89
    v_cvt_pk_bf16_f32 v81, v90, v91
    v_cvt_pk_bf16_f32 v82, v92, v93
    s_waitcnt vmcnt(14)
    v_mfma_f32_32x32x16_bf16 v[160:175], v[56:59], v[132:135], v[160:175]
    ds_read_b64_tr_b16 v[52:53], v3 offset:2048
    ds_read_b64_tr_b16 v[54:55], v3 offset:3072
    s_waitcnt lgkmcnt(6)
    buffer_load_dwordx4 v9, s[88:91], s39 offen offset:1024 lds
    v_cvt_pk_bf16_f32 v83, v94, v95
    buffer_store_dwordx4 v[80:83], v7, s[20:23], s60 offen sc1
    s_cmp_lg_u32 s63, 0
    s_cbranch_scc1 L_reducer
    v_mfma_f32_32x32x16_bf16 v[176:191], v[60:63], v[132:135], v[176:191]
    ds_read_b64_tr_b16 v[56:57], v4 offset:2048
    ds_read_b64_tr_b16 v[58:59], v4 offset:3072
    s_waitcnt lgkmcnt(6)
    v_or_b32 v3, 32768, v14
    v_xor_b32 v4, 32832, v14
    s_barrier
    s_waitcnt vmcnt(15)
    v_mfma_f32_32x32x16_bf16 v[160:175], v[248:251], v[136:139], v[160:175]
    ds_read_b64_tr_b16 v[60:61], v3
    ds_read_b64_tr_b16 v[62:63], v3 offset:1024
    s_waitcnt lgkmcnt(6)
    s_mul_i32 s39, s58, 114688
    s_mul_i32 m0, s85, 401408
    s_add_u32 s39, s39, m0
    s_add_u32 s39, s39, 114688
    s_add_u32 m0, s40, 0
    s_nop 0
    buffer_load_dwordx4 v8, s[88:91], s39 offen lds
    v_mfma_f32_32x32x16_bf16 v[176:191], v[48:51], v[136:139], v[176:191]
    ds_read_b64_tr_b16 v[248:249], v4
    ds_read_b64_tr_b16 v[250:251], v4 offset:1024
    s_waitcnt lgkmcnt(6)
    buffer_load_dwordx4 v9, s[88:91], s39 offen offset:1024 lds
    s_waitcnt vmcnt(16)
    v_mfma_f32_32x32x16_bf16 v[160:175], v[52:55], v[140:143], v[160:175]
    ds_read_b64_tr_b16 v[48:49], v3 offset:2048
    ds_read_b64_tr_b16 v[50:51], v3 offset:3072
    s_waitcnt lgkmcnt(6)
    v_mfma_f32_32x32x16_bf16 v[176:191], v[56:59], v[140:143], v[176:191]
    ds_read_b64_tr_b16 v[52:53], v4 offset:2048
    ds_read_b64_tr_b16 v[54:55], v4 offset:3072
    s_waitcnt lgkmcnt(6)
    v_or_b32 v3, 81920, v14
    v_xor_b32 v4, 81984, v14
    s_barrier
    s_waitcnt vmcnt(15)
    v_mfma_f32_32x32x16_bf16 v[160:175], v[60:63], v[144:147], v[160:175]
    ds_read_b64_tr_b16 v[56:57], v3
    ds_read_b64_tr_b16 v[58:59], v3 offset:1024
    s_waitcnt lgkmcnt(6)
    s_mul_i32 s69, s70, 20480
    s_mul_i32 s74, s84, 28672
    s_add_u32 s69, s69, s74
    s_add_u32 s69, s69, 36864
    buffer_load_dwordx4 v[192:195], v6, s[20:23], s69 offen sc1
    v_mfma_f32_32x32x16_bf16 v[176:191], v[248:251], v[144:147], v[176:191]
    ds_read_b64_tr_b16 v[60:61], v4
    ds_read_b64_tr_b16 v[62:63], v4 offset:1024
    s_waitcnt lgkmcnt(6)
    buffer_load_dwordx4 v[196:199], v6, s[20:23], s69 offen offset:1024 sc1
    s_waitcnt vmcnt(16)
    v_mfma_f32_32x32x16_bf16 v[160:175], v[48:51], v[148:151], v[160:175]
    ds_read_b64_tr_b16 v[248:249], v3 offset:2048
    ds_read_b64_tr_b16 v[250:251], v3 offset:3072
    s_waitcnt lgkmcnt(6)
    s_mul_i32 s69, s70, 20480
    s_mul_i32 s74, s85, 28672
    s_add_u32 s69, s69, s74
    s_add_u32 s69, s69, 36864
    buffer_load_dwordx4 v[200:203], v6, s[20:23], s69 offen sc1
    v_mfma_f32_32x32x16_bf16 v[176:191], v[52:55], v[148:151], v[176:191]
    ds_read_b64_tr_b16 v[48:49], v4 offset:2048
    ds_read_b64_tr_b16 v[50:51], v4 offset:3072
    s_waitcnt lgkmcnt(6)
    buffer_load_dwordx4 v[204:207], v6, s[20:23], s69 offen offset:1024 sc1
    v_or_b32 v3, 49152, v14
    v_xor_b32 v4, 49216, v14
    s_barrier
    s_cmp_lg_u32 s3, 0
    s_cbranch_scc1 L_w029
    buffer_load_dword v252, off, s[20:23], s81 sc1
L_w029:
    s_waitcnt vmcnt(17)
    v_mfma_f32_32x32x16_bf16 v[160:175], v[56:59], v[152:155], v[160:175]
    ds_read_b64_tr_b16 v[52:53], v3
    ds_read_b64_tr_b16 v[54:55], v3 offset:1024
    s_waitcnt lgkmcnt(6)
    s_mul_i32 s69, s70, 20480
    s_mul_i32 s74, s86, 28672
    s_add_u32 s69, s69, s74
    s_add_u32 s69, s69, 36864
    buffer_load_dwordx4 v[208:211], v6, s[20:23], s69 offen sc1
    v_mfma_f32_32x32x16_bf16 v[176:191], v[60:63], v[152:155], v[176:191]
    ds_read_b64_tr_b16 v[56:57], v4
    ds_read_b64_tr_b16 v[58:59], v4 offset:1024
    s_waitcnt lgkmcnt(6)
    buffer_load_dwordx4 v[212:215], v6, s[20:23], s69 offen offset:1024 sc1
    s_waitcnt vmcnt(18)
    v_mfma_f32_32x32x16_bf16 v[160:175], v[248:251], v[156:159], v[160:175]
    ds_read_b64_tr_b16 v[60:61], v3 offset:2048
    ds_read_b64_tr_b16 v[62:63], v3 offset:3072
    s_waitcnt lgkmcnt(6)
    s_mul_i32 s69, s70, 20480
    s_mul_i32 s74, s87, 28672
    s_add_u32 s69, s69, s74
    s_add_u32 s69, s69, 36864
    buffer_load_dwordx4 v[216:219], v6, s[20:23], s69 offen sc1
    v_mfma_f32_32x32x16_bf16 v[176:191], v[48:51], v[156:159], v[176:191]
    ds_read_b64_tr_b16 v[248:249], v4 offset:2048
    ds_read_b64_tr_b16 v[250:251], v4 offset:3072
    s_waitcnt lgkmcnt(6)
    buffer_load_dwordx4 v[220:223], v6, s[20:23], s69 offen offset:1024 sc1
    v_or_b32 v3, 65536, v14
    v_xor_b32 v4, 65600, v14
    s_waitcnt vmcnt(17)
    s_barrier
    s_waitcnt vmcnt(6)
    v_max3_u32 v254, v192, v195, v196
    v_max_u32 v254, v254, v199
    v_cmp_eq_u32 vcc, -1, v254
    s_cbranch_vccnz L_retry41
L_back42:
    v_mfma_f32_32x32x16_bf16 v[160:175], v[52:55], v[192:195], v[160:175]
    ds_read_b64_tr_b16 v[48:49], v3
    ds_read_b64_tr_b16 v[50:51], v3 offset:1024
    s_waitcnt lgkmcnt(6)
    s_mul_i32 s39, s58, 114688
    s_mul_i32 m0, s86, 401408
    s_add_u32 s39, s39, m0
    s_add_u32 s39, s39, 114688
    s_add_u32 m0, s40, 16384
    s_nop 0
    buffer_load_dwordx4 v8, s[88:91], s39 offen lds
    v_mfma_f32_32x32x16_bf16 v[176:191], v[56:59], v[192:195], v[176:191]
    ds_read_b64_tr_b16 v[52:53], v4
    ds_read_b64_tr_b16 v[54:55], v4 offset:1024
    s_waitcnt lgkmcnt(6)
    buffer_load_dwordx4 v9, s[88:91], s39 offen offset:1024 lds
    v_mfma_f32_32x32x16_bf16 v[160:175], v[60:63], v[196:199], v[160:175]
    ds_read_b64_tr_b16 v[56:57], v3 offset:2048
    ds_read_b64_tr_b16 v[58:59], v3 offset:3072
    s_waitcnt lgkmcnt(6)
    s_mul_i32 s39, s58, 114688
    s_mul_i32 m0, s87, 401408
    s_add_u32 s39, s39, m0
    s_add_u32 s39, s39, 114688
    s_add_u32 m0, s40, 32768
    s_nop 0
    buffer_load_dwordx4 v8, s[88:91], s39 offen lds
    v_mfma_f32_32x32x16_bf16 v[176:191], v[248:251], v[196:199], v[176:191]
    ds_read_b64_tr_b16 v[60:61], v4 offset:2048
    ds_read_b64_tr_b16 v[62:63], v4 offset:3072
    s_waitcnt lgkmcnt(6)
    buffer_load_dwordx4 v9, s[88:91], s39 offen offset:1024 lds
    v_or_b32 v3, 98304, v14
    v_xor_b32 v4, 98368, v14
    s_cmp_lg_u32 s3, 0
    s_cbranch_scc1 L_w032
    s_waitcnt vmcnt(8)
    s_mov_b32 s73, 0
L_sp30:
    v_readfirstlane_b32 s43, v252
    s_nop 1
    s_and_b32 s43, s43, 0xff00
    s_cmp_eq_u32 s43, 0x800
    s_cbranch_scc1 L_ok31
    s_add_u32 s73, s73, 1
    s_cmp_gt_u32 s73, 100000
    s_cbranch_scc1 L_ok31
    s_sleep 2
    buffer_load_dword v252, off, s[20:23], s81 sc1
    s_waitcnt vmcnt(0)
    s_branch L_sp30
L_ok31:
L_w032:
    s_barrier
    s_waitcnt vmcnt(8)
    v_max3_u32 v254, v200, v203, v204
    v_max_u32 v254, v254, v207
    v_cmp_eq_u32 vcc, -1, v254
    s_cbranch_vccnz L_retry44
L_back45:
    v_mfma_f32_32x32x16_bf16 v[160:175], v[48:51], v[200:203], v[160:175]
    ds_read_b64_tr_b16 v[248:249], v3
    ds_read_b64_tr_b16 v[250:251], v3 offset:1024
    s_waitcnt lgkmcnt(6)
    s_mul_i32 s39, s58, 401408
    s_mul_i32 m0, s64, 802816
    s_add_u32 s39, s39, m0
    s_add_u32 s39, s39, 172032
    s_add_u32 m0, s40, 81920
    s_nop 0
    buffer_load_dwordx4 v8, s[88:91], s39 offen lds
    v_mfma_f32_32x32x16_bf16 v[176:191], v[52:55], v[200:203], v[176:191]
    ds_read_b64_tr_b16 v[48:49], v4
    ds_read_b64_tr_b16 v[50:51], v4 offset:1024
    s_waitcnt lgkmcnt(6)
    buffer_load_dwordx4 v9, s[88:91], s39 offen offset:1024 lds
    v_mfma_f32_32x32x16_bf16 v[160:175], v[56:59], v[204:207], v[160:175]
    ds_read_b64_tr_b16 v[52:53], v3 offset:2048
    ds_read_b64_tr_b16 v[54:55], v3 offset:3072
    s_waitcnt lgkmcnt(6)
    s_mul_i32 s39, s58, 401408
    s_mul_i32 m0, s65, 802816
    s_add_u32 s39, s39, m0
    s_add_u32 s39, s39, 172032
    s_add_u32 m0, s40, 49152
    s_nop 0
    buffer_load_dwordx4 v8, s[88:91], s39 offen lds
    v_mfma_f32_32x32x16_bf16 v[176:191], v[60:63], v[204:207], v[176:191]
    ds_read_b64_tr_b16 v[56:57], v4 offset:2048
    ds_read_b64_tr_b16 v[58:59], v4 offset:3072
    s_waitcnt lgkmcnt(6)
    buffer_load_dwordx4 v9, s[88:91], s39 offen offset:1024 lds
    v_or_b32 v3, 114688, v14
    v_xor_b32 v4, 114752, v14
    s_barrier
    s_waitcnt vmcnt(10)
    v_max3_u32 v254, v208, v211, v212
    v_max_u32 v254, v254, v215
    v_cmp_eq_u32 vcc, -1, v254
    s_cbranch_vccnz L_retry47
L_back48:
    v_mfma_f32_32x32x16_bf16 v[160:175], v[248:251], v[208:211], v[160:175]
    ds_read_b64_tr_b16 v[60:61], v3
    ds_read_b64_tr_b16 v[62:63], v3 offset:1024
    s_waitcnt lgkmcnt(6)
    s_mul_i32 s69, s70, 8192
    s_mul_i32 s74, s84, 28672
    s_add_u32 s69, s69, s74
    s_add_u32 s69, s69, 40960
    buffer_load_dwordx4 v[128:131], v6, s[20:23], s69 offen sc1
    v_mfma_f32_32x32x16_bf16 v[176:191], v[48:51], v[208:211], v[176:191]
    ds_read_b64_tr_b16 v[248:249], v4
    ds_read_b64_tr_b16 v[250:251], v4 offset:1024
    s_waitcnt lgkmcnt(6)
    buffer_load_dwordx4 v[132:135], v6, s[20:23], s69 offen offset:1024 sc1
    v_mfma_f32_32x32x16_bf16 v[160:175], v[52:55], v[212:215], v[160:175]
    ds_read_b64_tr_b16 v[48:49], v3 offset:2048
    ds_read_b64_tr_b16 v[50:51], v3 offset:3072
    s_waitcnt lgkmcnt(6)
    s_mul_i32 s69, s70, 8192
    s_mul_i32 s74, s85, 28672
    s_add_u32 s69, s69, s74
    s_add_u32 s69, s69, 40960
    buffer_load_dwordx4 v[136:139], v6, s[20:23], s69 offen sc1
    v_mfma_f32_32x32x16_bf16 v[176:191], v[56:59], v[212:215], v[176:191]
    ds_read_b64_tr_b16 v[52:53], v4 offset:2048
    ds_read_b64_tr_b16 v[54:55], v4 offset:3072
    s_waitcnt lgkmcnt(6)
    buffer_load_dwordx4 v[140:143], v6, s[20:23], s69 offen offset:1024 sc1
    v_or_b32 v3, 131072, v14
    v_xor_b32 v4, 131136, v14
    s_barrier
    s_waitcnt vmcnt(12)
    v_max3_u32 v254, v216, v219, v220
    v_max_u32 v254, v254, v223
    v_cmp_eq_u32 vcc, -1, v254
    s_cbranch_vccnz L_retry50
L_back51:
    v_mfma_f32_32x32x16_bf16 v[160:175], v[60:63], v[216:219], v[160:175]
    ds_read_b64_tr_b16 v[56:57], v3
    ds_read_b64_tr_b16 v[58:59], v3 offset:1024
    s_waitcnt lgkmcnt(6)
    s_mul_i32 s69, s70, 8192
    s_mul_i32 s74, s86, 28672
    s_add_u32 s69, s69, s74
    s_add_u32 s69, s69, 40960
    buffer_load_dwordx4 v[144:147], v6, s[20:23], s69 offen sc1
    v_mfma_f32_32x32x16_bf16 v[176:191], v[248:251], v[216:219], v[176:191]
    ds_read_b64_tr_b16 v[60:61], v4
    ds_read_b64_tr_b16 v[62:63], v4 offset:1024
    s_waitcnt lgkmcnt(6)
    buffer_load_dwordx4 v[148:151], v6, s[20:23], s69 offen offset:1024 sc1
    v_mfma_f32_32x32x16_bf16 v[160:175], v[48:51], v[220:223], v[160:175]
    ds_read_b64_tr_b16 v[248:249], v3 offset:2048
    ds_read_b64_tr_b16 v[250:251], v3 offset:3072
    s_waitcnt lgkmcnt(6)
    s_mul_i32 s69, s70, 8192
    s_mul_i32 s74, s87, 28672
    s_add_u32 s69, s69, s74
    s_add_u32 s69, s69, 40960
    buffer_load_dwordx4 v[152:155], v6, s[20:23], s69 offen sc1
    v_mfma_f32_32x32x16_bf16 v[176:191], v[52:55], v[220:223], v[176:191]
    ds_read_b64_tr_b16 v[48:49], v4 offset:2048
    ds_read_b64_tr_b16 v[50:51], v4 offset:3072
    s_waitcnt lgkmcnt(6)
    buffer_load_dwordx4 v[156:159], v6, s[20:23], s69 offen offset:1024 sc1
    v_or_b32 v3, 0, v14
    v_xor_b32 v4, 64, v14
    s_barrier
    s_waitcnt vmcnt(6)
    v_max3_u32 v254, v128, v131, v132
    v_max_u32 v254, v254, v135
    v_cmp_eq_u32 vcc, -1, v254
    s_cbranch_vccnz L_retry53
L_back54:
    v_mfma_f32_32x32x16_bf16 v[160:175], v[56:59], v[128:131], v[160:175]
    ds_read_b64_tr_b16 v[52:53], v3
    ds_read_b64_tr_b16 v[54:55], v3 offset:1024
    s_waitcnt lgkmcnt(6)
    s_mul_i32 s69, s70, 28672
    s_mul_i32 s74, s64, 57344
    s_add_u32 s69, s69, s74
    s_add_u32 s69, s69, 45056
    buffer_load_dwordx4 v[192:195], v6, s[20:23], s69 offen sc1
    v_mfma_f32_32x32x16_bf16 v[176:191], v[60:63], v[128:131], v[176:191]
    ds_read_b64_tr_b16 v[56:57], v4
    ds_read_b64_tr_b16 v[58:59], v4 offset:1024
    s_waitcnt lgkmcnt(6)
    buffer_load_dwordx4 v[196:199], v6, s[20:23], s69 offen offset:1024 sc1
    v_mfma_f32_32x32x16_bf16 v[160:175], v[248:251], v[132:135], v[160:175]
    ds_read_b64_tr_b16 v[60:61], v3 offset:2048
    ds_read_b64_tr_b16 v[62:63], v3 offset:3072
    s_waitcnt lgkmcnt(6)
    s_mul_i32 s69, s70, 28672
    s_mul_i32 s74, s65, 57344
    s_add_u32 s69, s69, s74
    s_add_u32 s69, s69, 45056
    buffer_load_dwordx4 v[200:203], v6, s[20:23], s69 offen sc1
    v_mfma_f32_32x32x16_bf16 v[176:191], v[48:51], v[132:135], v[176:191]
    ds_read_b64_tr_b16 v[248:249], v4 offset:2048
    ds_read_b64_tr_b16 v[250:251], v4 offset:3072
    s_waitcnt lgkmcnt(6)
    buffer_load_dwordx4 v[204:207], v6, s[20:23], s69 offen offset:1024 sc1
    v_or_b32 v3, 16384, v14
    v_xor_b32 v4, 16448, v14
    s_barrier
    s_waitcnt vmcnt(8)
    v_max3_u32 v254, v136, v139, v140
    v_max_u32 v254, v254, v143
    v_cmp_eq_u32 vcc, -1, v254
    s_cbranch_vccnz L_retry56
L_back57:
    v_mfma_f32_32x32x16_bf16 v[160:175], v[52:55], v[136:139], v[160:175]
    ds_read_b64_tr_b16 v[48:49], v3
    ds_read_b64_tr_b16 v[50:51], v3 offset:1024
    s_waitcnt lgkmcnt(6)
    s_mul_i32 s39, s58, 50176
    s_mul_i32 m0, s84, 100352
    s_add_u32 s39, s39, m0
    s_add_u32 m0, s40, 65536
    s_nop 0
    buffer_load_dwordx4 v10, s[92:95], s39 offen lds
    v_mfma_f32_32x32x16_bf16 v[176:191], v[56:59], v[136:139], v[176:191]
    ds_read_b64_tr_b16 v[52:53], v4
    ds_read_b64_tr_b16 v[54:55], v4 offset:1024
    s_waitcnt lgkmcnt(6)
    buffer_load_dwordx4 v11, s[92:95], s39 offen offset:1024 lds
    v_mfma_f32_32x32x16_bf16 v[160:175], v[60:63], v[140:143], v[160:175]
    ds_read_b64_tr_b16 v[56:57], v3 offset:2048
    ds_read_b64_tr_b16 v[58:59], v3 offset:3072
    s_waitcnt lgkmcnt(6)
    s_mul_i32 s39, s58, 50176
    s_mul_i32 m0, s85, 100352
    s_add_u32 s39, s39, m0
    s_add_u32 m0, s40, 98304
    s_nop 0
    buffer_load_dwordx4 v10, s[92:95], s39 offen lds
    v_mfma_f32_32x32x16_bf16 v[176:191], v[248:251], v[140:143], v[176:191]
    ds_read_b64_tr_b16 v[60:61], v4 offset:2048
    ds_read_b64_tr_b16 v[62:63], v4 offset:3072
    s_waitcnt lgkmcnt(6)
    buffer_load_dwordx4 v11, s[92:95], s39 offen offset:1024 lds
    v_or_b32 v3, 32768, v14
    v_xor_b32 v4, 32832, v14
    s_barrier
    s_waitcnt vmcnt(10)
    v_max3_u32 v254, v144, v147, v148
    v_max_u32 v254, v254, v151
    v_cmp_eq_u32 vcc, -1, v254
    s_cbranch_vccnz L_retry59
L_back60:
    v_mfma_f32_32x32x16_bf16 v[160:175], v[48:51], v[144:147], v[160:175]
    ds_read_b64_tr_b16 v[248:249], v3
    ds_read_b64_tr_b16 v[250:251], v3 offset:1024
    s_waitcnt lgkmcnt(6)
    s_mul_i32 s39, s58, 50176
    s_mul_i32 m0, s86, 100352
    s_add_u32 s39, s39, m0
    s_add_u32 m0, s40, 114688
    s_nop 0
    buffer_load_dwordx4 v10, s[92:95], s39 offen lds
    v_mfma_f32_32x32x16_bf16 v[176:191], v[52:55], v[144:147], v[176:191]
    ds_read_b64_tr_b16 v[48:49], v4
    ds_read_b64_tr_b16 v[50:51], v4 offset:1024
    s_waitcnt lgkmcnt(6)
    buffer_load_dwordx4 v11, s[92:95], s39 offen offset:1024 lds
    v_mfma_f32_32x32x16_bf16 v[160:175], v[56:59], v[148:151], v[160:175]
    ds_read_b64_tr_b16 v[52:53], v3 offset:2048
    ds_read_b64_tr_b16 v[54:55], v3 offset:3072
    s_waitcnt lgkmcnt(6)
    s_mul_i32 s39, s58, 50176
    s_mul_i32 m0, s87, 100352
    s_add_u32 s39, s39, m0
    s_add_u32 m0, s40, 131072
    s_nop 0
    buffer_load_dwordx4 v10, s[92:95], s39 offen lds
    v_mfma_f32_32x32x16_bf16 v[176:191], v[60:63], v[148:151], v[176:191]
    ds_read_b64_tr_b16 v[56:57], v4 offset:2048
    ds_read_b64_tr_b16 v[58:59], v4 offset:3072
    s_waitcnt lgkmcnt(6)
    buffer_load_dwordx4 v11, s[92:95], s39 offen offset:1024 lds
    v_or_b32 v3, 81920, v14
    v_xor_b32 v4, 81984, v14
    s_barrier
    s_waitcnt vmcnt(12)
    v_max3_u32 v254, v152, v155, v156
    v_max_u32 v254, v254, v159
    v_cmp_eq_u32 vcc, -1, v254
    s_cbranch_vccnz L_retry62
L_back63:
    v_mfma_f32_32x32x16_bf16 v[160:175], v[248:251], v[152:155], v[160:175]
    ds_read_b64_tr_b16 v[60:61], v3
    ds_read_b64_tr_b16 v[62:63], v3 offset:1024
    s_waitcnt lgkmcnt(6)
    v_mfma_f32_32x32x16_bf16 v[176:191], v[48:51], v[152:155], v[176:191]
    ds_read_b64_tr_b16 v[248:249], v4
    ds_read_b64_tr_b16 v[250:251], v4 offset:1024
    s_waitcnt lgkmcnt(6)
    v_mfma_f32_32x32x16_bf16 v[160:175], v[52:55], v[156:159], v[160:175]
    ds_read_b64_tr_b16 v[48:49], v3 offset:2048
    ds_read_b64_tr_b16 v[50:51], v3 offset:3072
    s_waitcnt lgkmcnt(6)
    v_mfma_f32_32x32x16_bf16 v[176:191], v[56:59], v[156:159], v[176:191]
    ds_read_b64_tr_b16 v[52:53], v4 offset:2048
    ds_read_b64_tr_b16 v[54:55], v4 offset:3072
    s_waitcnt lgkmcnt(6)
    v_or_b32 v3, 49152, v14
    v_xor_b32 v4, 49216, v14
    s_barrier
    s_waitcnt vmcnt(10)
    v_max3_u32 v254, v192, v195, v196
    v_max_u32 v254, v254, v199
    v_cmp_eq_u32 vcc, -1, v254
    s_cbranch_vccnz L_retry65
L_back66:
    v_mfma_f32_32x32x16_bf16 v[160:175], v[60:63], v[192:195], v[160:175]
    ds_read_b64_tr_b16 v[56:57], v3
    ds_read_b64_tr_b16 v[58:59], v3 offset:1024
    s_waitcnt lgkmcnt(6)
    v_and_b32 v2, 31, v1
    v_lshlrev_b32 v2, 2, v2
    buffer_load_dword v5, v2, s[20:23], s79 offen sc1
    v_mfma_f32_32x32x16_bf16 v[176:191], v[248:251], v[192:195], v[176:191]
    ds_read_b64_tr_b16 v[60:61], v4
    ds_read_b64_tr_b16 v[62:63], v4 offset:1024
    s_waitcnt lgkmcnt(6)
    s_mul_i32 s69, s70, 4096
    s_mul_i32 s74, s84, 8192
    s_add_u32 s69, s69, s74
    buffer_load_dwordx4 v[208:211], v6, s[20:23], s69 offen sc1
    v_mfma_f32_32x32x16_bf16 v[160:175], v[48:51], v[196:199], v[160:175]
    ds_read_b64_tr_b16 v[248:249], v3 offset:2048
    ds_read_b64_tr_b16 v[250:251], v3 offset:3072
    s_waitcnt lgkmcnt(6)
    buffer_load_dwordx4 v[212:215], v6, s[20:23], s69 offen offset:1024 sc1
    v_mfma_f32_32x32x16_bf16 v[176:191], v[52:55], v[196:199], v[176:191]
    ds_read_b64_tr_b16 v[48:49], v4 offset:2048
    ds_read_b64_tr_b16 v[50:51], v4 offset:3072
    s_waitcnt lgkmcnt(6)
    s_mul_i32 s69, s70, 4096
    s_mul_i32 s74, s85, 8192
    s_add_u32 s69, s69, s74
    buffer_load_dwordx4 v[216:219], v6, s[20:23], s69 offen sc1
    v_or_b32 v3, 65536, v14
    v_xor_b32 v4, 65600, v14
    s_waitcnt vmcnt(10)
    s_barrier
    v_max3_u32 v254, v200, v203, v204
    v_max_u32 v254, v254, v207
    v_cmp_eq_u32 vcc, -1, v254
    s_cbranch_vccnz L_retry68
L_back69:
    v_mfma_f32_32x32x16_bf16 v[160:175], v[56:59], v[200:203], v[160:175]
    ds_read_b64_tr_b16 v[52:53], v3
    ds_read_b64_tr_b16 v[54:55], v3 offset:1024
    s_waitcnt lgkmcnt(6)
    buffer_load_dwordx4 v[220:223], v6, s[20:23], s69 offen offset:1024 sc1
    v_mfma_f32_32x32x16_bf16 v[176:191], v[60:63], v[200:203], v[176:191]
    ds_read_b64_tr_b16 v[56:57], v4
    ds_read_b64_tr_b16 v[58:59], v4 offset:1024
    s_waitcnt lgkmcnt(6)
    s_mul_i32 s69, s70, 4096
    s_mul_i32 s74, s86, 8192
    s_add_u32 s69, s69, s74
    buffer_load_dwordx4 v[128:131], v6, s[20:23], s69 offen sc1
    v_mfma_f32_32x32x16_bf16 v[160:175], v[248:251], v[204:207], v[160:175]
    ds_read_b64_tr_b16 v[60:61], v3 offset:2048
    ds_read_b64_tr_b16 v[62:63], v3 offset:3072
    s_waitcnt lgkmcnt(6)
    buffer_load_dwordx4 v[132:135], v6, s[20:23], s69 offen offset:1024 sc1
    v_mfma_f32_32x32x16_bf16 v[176:191], v[48:51], v[204:207], v[176:191]
    ds_read_b64_tr_b16 v[248:249], v4 offset:2048
    ds_read_b64_tr_b16 v[250:251], v4 offset:3072
    s_waitcnt lgkmcnt(6)
    s_mul_i32 s69, s70, 4096
    s_mul_i32 s74, s87, 8192
    s_add_u32 s69, s69, s74
    buffer_load_dwordx4 v[136:139], v6, s[20:23], s69 offen sc1
    v_or_b32 v3, 98304, v14
    v_xor_b32 v4, 98368, v14
    s_waitcnt vmcnt(12)
    s_barrier
    s_waitcnt vmcnt(5)
    v_max3_u32 v254, v208, v211, v212
    v_max_u32 v254, v254, v215
    v_cmp_eq_u32 vcc, -1, v254
    s_cbranch_vccnz L_retry71
L_back72:
    v_cmp_eq_u32 vcc, -1, v5
    s_cbranch_vccnz L_retry35
L_back36:
    v_mul_f32 v160, v160, v5
    v_mul_f32 v161, v161, v5
    v_mul_f32 v162, v162, v5
    v_mul_f32 v163, v163, v5
    v_mul_f32 v164, v164, v5
    v_mul_f32 v165, v165, v5
    v_mul_f32 v166, v166, v5
    v_mul_f32 v167, v167, v5
    v_mul_f32 v168, v168, v5
    v_mul_f32 v169, v169, v5
    v_mul_f32 v170, v170, v5
    v_mul_f32 v171, v171, v5
    v_mul_f32 v172, v172, v5
    v_mul_f32 v173, v173, v5
    v_mul_f32 v174, v174, v5
    v_mul_f32 v175, v175, v5
    v_mul_f32 v176, v176, v5
    v_mul_f32 v177, v177, v5
    v_mul_f32 v178, v178, v5
    v_mul_f32 v179, v179, v5
    v_mul_f32 v180, v180, v5
    v_mul_f32 v181, v181, v5
    v_mul_f32 v182, v182, v5
    v_mul_f32 v183, v183, v5
    v_mul_f32 v184, v184, v5
    v_mul_f32 v185, v185, v5
    v_mul_f32 v186, v186, v5
    v_mul_f32 v187, v187, v5
    v_mul_f32 v188, v188, v5
    v_mul_f32 v189, v189, v5
    v_mul_f32 v190, v190, v5
    v_mul_f32 v191, v191, v5
    v_mfma_f32_32x32x16_bf16 v[160:175], v[52:55], v[208:211], v[160:175]
    ds_read_b64_tr_b16 v[48:49], v3
    ds_read_b64_tr_b16 v[50:51], v3 offset:1024
    s_waitcnt lgkmcnt(6)
    buffer_load_dwordx4 v[140:143], v6, s[20:23], s69 offen offset:1024 sc1
    v_mfma_f32_32x32x16_bf16 v[176:191], v[56:59], v[208:211], v[176:191]
    ds_read_b64_tr_b16 v[52:53], v4
    ds_read_b64_tr_b16 v[54:55], v4 offset:1024
    s_waitcnt lgkmcnt(6)
    v_and_b32 v20, 31, v1
    v_and_b32 v19, 7, v1
    v_lshrrev_b32 v23, 5, v1
    v_xor_b32 v19, v19, v23
    v_lshlrev_b32 v19, 4, v19
    v_lshl_add_u32 v20, v20, 8, v19
    s_lshl_b32 s71, s3, 13
    s_add_u32 s71, s71, 0
    v_add_u32 v20, s71, v20
    v_xor_b32 v24, 0, v20
    v_xor_b32 v25, 32, v20
    v_xor_b32 v26, 64, v20
    v_xor_b32 v27, 96, v20
    v_xor_b32 v28, 128, v20
    v_xor_b32 v29, 160, v20
    v_xor_b32 v30, 192, v20
    v_mfma_f32_32x32x16_bf16 v[160:175], v[60:63], v[212:215], v[160:175]
    ds_read_b64_tr_b16 v[56:57], v3 offset:2048
    ds_read_b64_tr_b16 v[58:59], v3 offset:3072
    s_waitcnt lgkmcnt(6)
    v_xor_b32 v31, 224, v20
    v_lshrrev_b32 v23, 3, v1
    v_and_b32 v19, 7, v1
    v_lshlrev_b32 v21, 1, v19
    v_xor_b32 v21, v21, v23
    v_lshlrev_b32 v21, 4, v21
    v_lshl_add_u32 v21, v23, 8, v21
    s_lshl_b32 s71, s58, 15
    s_and_b32 s50, s3, 3
    s_lshl_b32 s72, s50, 11
    s_add_u32 s71, s71, s72
    s_add_u32 s71, s71, 0
    v_add_u32 v21, s71, v21
    v_xor_b32 v22, 16, v21
    v_mul_u32_u24 v23, 896, v23
    v_lshl_add_u32 v23, v19, 4, v23
    s_lshl_b32 s71, s61, 6
    s_lshl_b32 s72, s58, 5
    s_add_u32 s71, s71, s72
    s_lshl_b32 s72, s50, 3
    s_add_u32 s71, s71, s72
    s_mul_i32 s71, s71, 896
    s_lshl_b32 s72, s62, 7
    s_add_u32 s71, s71, s72
    v_mfma_f32_32x32x16_bf16 v[176:191], v[248:251], v[212:215], v[176:191]
    ds_read_b64_tr_b16 v[60:61], v4 offset:2048
    ds_read_b64_tr_b16 v[62:63], v4 offset:3072
    s_waitcnt lgkmcnt(6)
    v_xor_b32 v3, 114688, v14
    s_barrier
    s_waitcnt vmcnt(4)
    v_max3_u32 v254, v216, v219, v220
    v_max_u32 v254, v254, v223
    v_cmp_eq_u32 vcc, -1, v254
    s_cbranch_vccnz L_retry74
L_back75:
    v_mfma_f32_32x32x16_bf16 v[160:175], v[48:51], v[216:219], v[160:175]
    ds_read_b64_tr_b16 v[248:249], v3
    ds_read_b64_tr_b16 v[250:251], v3 offset:1024
    s_waitcnt lgkmcnt(6)
    v_mfma_f32_32x32x16_bf16 v[176:191], v[52:55], v[216:219], v[176:191]
    ds_read_b64_tr_b16 v[48:49], v3 offset:2048
    ds_read_b64_tr_b16 v[50:51], v3 offset:3072
    s_waitcnt lgkmcnt(6)
    v_xor_b32 v4, 131072, v14
    v_mfma_f32_32x32x16_bf16 v[160:175], v[56:59], v[220:223], v[160:175]
    ds_read_b64_tr_b16 v[52:53], v4
    ds_read_b64_tr_b16 v[54:55], v4 offset:1024
    s_waitcnt lgkmcnt(6)
    v_mfma_f32_32x32x16_bf16 v[176:191], v[60:63], v[220:223], v[176:191]
    ds_read_b64_tr_b16 v[56:57], v4 offset:2048
    ds_read_b64_tr_b16 v[58:59], v4 offset:3072
    s_waitcnt lgkmcnt(6)
    v_xor_b32 v3, 114752, v14
    s_waitcnt vmcnt(2)
    v_max3_u32 v254, v128, v131, v132
    s_waitcnt vmcnt(1)
    v_max3_u32 v254, v254, v135, v136
    s_waitcnt vmcnt(0)
    v_max3_u32 v254, v254, v139, v140
    v_max_u32 v254, v254, v143
    v_cmp_eq_u32 vcc, -1, v254
    s_cbranch_vccnz L_retry77
L_back78:
    v_mfma_f32_32x32x16_bf16 v[160:175], v[248:251], v[128:131], v[160:175]
    ds_read_b64_tr_b16 v[60:61], v3
    ds_read_b64_tr_b16 v[62:63], v3 offset:1024
    s_waitcnt lgkmcnt(6)
    v_mfma_f32_32x32x16_bf16 v[160:175], v[48:51], v[132:135], v[160:175]
    ds_read_b64_tr_b16 v[248:249], v3 offset:2048
    ds_read_b64_tr_b16 v[250:251], v3 offset:3072
    s_waitcnt lgkmcnt(6)
    v_xor_b32 v4, 131136, v14
    v_mfma_f32_32x32x16_bf16 v[160:175], v[52:55], v[136:139], v[160:175]
    ds_read_b64_tr_b16 v[48:49], v4
    ds_read_b64_tr_b16 v[50:51], v4 offset:1024
    s_waitcnt lgkmcnt(6)
    v_mfma_f32_32x32x16_bf16 v[160:175], v[56:59], v[140:143], v[160:175]
    ds_read_b64_tr_b16 v[52:53], v4 offset:2048
    ds_read_b64_tr_b16 v[54:55], v4 offset:3072
    s_waitcnt lgkmcnt(6)
    v_mfma_f32_32x32x16_bf16 v[176:191], v[60:63], v[128:131], v[176:191]
    s_waitcnt lgkmcnt(4)
    v_mfma_f32_32x32x16_bf16 v[176:191], v[248:251], v[132:135], v[176:191]
    s_waitcnt lgkmcnt(2)
    s_nop 4
    ds_write_b128 v24, v[160:163]
    ds_write_b128 v25, v[164:167]
    v_mfma_f32_32x32x16_bf16 v[176:191], v[48:51], v[136:139], v[176:191]
    s_waitcnt lgkmcnt(2)
    ds_write_b128 v26, v[168:171]
    ds_write_b128 v27, v[172:175]
    v_mfma_f32_32x32x16_bf16 v[176:191], v[52:55], v[140:143], v[176:191]
    s_nop 11
    ds_write_b128 v28, v[176:179]
    ds_write_b128 v29, v[180:183]
    ds_write_b128 v30, v[184:187]
    ds_write_b128 v31, v[188:191]
    s_waitcnt lgkmcnt(0)
    s_barrier
    ds_read_b128 v[64:67], v21
    ds_read_b128 v[68:71], v22
    ds_read_b128 v[72:75], v21 offset:8192
    ds_read_b128 v[76:79], v22 offset:8192
    ds_read_b128 v[80:83], v21 offset:16384
    ds_read_b128 v[84:87], v22 offset:16384
    ds_read_b128 v[88:91], v21 offset:24576
    ds_read_b128 v[92:95], v22 offset:24576
    s_waitcnt lgkmcnt(5)
    v_add_f32 v64, v64, v72
    v_add_f32 v65, v65, v73
    v_add_f32 v66, v66, v74
    v_add_f32 v67, v67, v75
    s_waitcnt lgkmcnt(4)
    v_add_f32 v68, v68, v76
    v_add_f32 v69, v69, v77
    v_add_f32 v70, v70, v78
    v_add_f32 v71, v71, v79
    s_waitcnt lgkmcnt(1)
    v_add_f32 v80, v80, v88
    v_add_f32 v81, v81, v89
    v_add_f32 v82, v82, v90
    v_add_f32 v83, v83, v91
    s_waitcnt lgkmcnt(0)
    v_add_f32 v84, v84, v92
    v_add_f32 v85, v85, v93
    v_add_f32 v86, v86, v94
    v_add_f32 v87, v87, v95
    v_add_f32 v64, v64, v80
    v_add_f32 v65, v65, v81
    v_add_f32 v66, v66, v82
    v_add_f32 v67, v67, v83
    v_add_f32 v68, v68, v84
    v_add_f32 v69, v69, v85
    v_add_f32 v70, v70, v86
    v_add_f32 v71, v71, v87
    v_cvt_pk_bf16_f32 v96, v64, v65
    v_cvt_pk_bf16_f32 v97, v66, v67
    v_cvt_pk_bf16_f32 v98, v68, v69
    v_cvt_pk_bf16_f32 v99, v70, v71
    buffer_store_dwordx4 v[96:99], v23, s[96:99], s71 offen
    s_endpgm
.p2align 6
L_reducer:
    s_endpgm
L_retry35:
    s_mov_b32 s73, 0
L_rl37:
    s_sleep 1
    buffer_load_dword v5, v2, s[20:23], s79 offen sc1
    s_waitcnt vmcnt(0)
    v_cmp_eq_u32 vcc, -1, v5
    s_cbranch_vccz L_back36
    s_add_u32 s73, s73, 1
    s_cmp_lt_u32 s73, 100000
    s_cbranch_scc1 L_rl37
    s_branch L_back36
L_retry41:
    s_mov_b32 s73, 0
L_rl43:
    s_sleep 1
    s_mul_i32 s75, s70, 20480
    s_mul_i32 s74, s84, 28672
    s_add_u32 s75, s75, s74
    s_add_u32 s75, s75, 36864
    buffer_load_dwordx4 v[192:195], v6, s[20:23], s75 offen sc1
    buffer_load_dwordx4 v[196:199], v6, s[20:23], s75 offen offset:1024 sc1
    s_mul_i32 s75, s70, 20480
    s_mul_i32 s74, s85, 28672
    s_add_u32 s75, s75, s74
    s_add_u32 s75, s75, 36864
    buffer_load_dwordx4 v[200:203], v6, s[20:23], s75 offen sc1
    buffer_load_dwordx4 v[204:207], v6, s[20:23], s75 offen offset:1024 sc1
    s_mul_i32 s75, s70, 20480
    s_mul_i32 s74, s86, 28672
    s_add_u32 s75, s75, s74
    s_add_u32 s75, s75, 36864
    buffer_load_dwordx4 v[208:211], v6, s[20:23], s75 offen sc1
    buffer_load_dwordx4 v[212:215], v6, s[20:23], s75 offen offset:1024 sc1
    s_mul_i32 s75, s70, 20480
    s_mul_i32 s74, s87, 28672
    s_add_u32 s75, s75, s74
    s_add_u32 s75, s75, 36864
    buffer_load_dwordx4 v[216:219], v6, s[20:23], s75 offen sc1
    buffer_load_dwordx4 v[220:223], v6, s[20:23], s75 offen offset:1024 sc1
    s_waitcnt vmcnt(0)
    v_max3_u32 v254, v192, v195, v196
    v_max_u32 v254, v254, v199
    v_cmp_eq_u32 vcc, -1, v254
    s_cbranch_vccz L_back42
    s_add_u32 s73, s73, 1
    s_cmp_lt_u32 s73, 100000
    s_cbranch_scc1 L_rl43
    s_branch L_back42
L_retry44:
    s_mov_b32 s73, 0
L_rl46:
    s_sleep 1
    s_mul_i32 s75, s70, 20480
    s_mul_i32 s74, s85, 28672
    s_add_u32 s75, s75, s74
    s_add_u32 s75, s75, 36864
    buffer_load_dwordx4 v[200:203], v6, s[20:23], s75 offen sc1
    buffer_load_dwordx4 v[204:207], v6, s[20:23], s75 offen offset:1024 sc1
    s_mul_i32 s75, s70, 20480
    s_mul_i32 s74, s86, 28672
    s_add_u32 s75, s75, s74
    s_add_u32 s75, s75, 36864
    buffer_load_dwordx4 v[208:211], v6, s[20:23], s75 offen sc1
    buffer_load_dwordx4 v[212:215], v6, s[20:23], s75 offen offset:1024 sc1
    s_mul_i32 s75, s70, 20480
    s_mul_i32 s74, s87, 28672
    s_add_u32 s75, s75, s74
    s_add_u32 s75, s75, 36864
    buffer_load_dwordx4 v[216:219], v6, s[20:23], s75 offen sc1
    buffer_load_dwordx4 v[220:223], v6, s[20:23], s75 offen offset:1024 sc1
    s_waitcnt vmcnt(0)
    v_max3_u32 v254, v200, v203, v204
    v_max_u32 v254, v254, v207
    v_cmp_eq_u32 vcc, -1, v254
    s_cbranch_vccz L_back45
    s_add_u32 s73, s73, 1
    s_cmp_lt_u32 s73, 100000
    s_cbranch_scc1 L_rl46
    s_branch L_back45
L_retry47:
    s_mov_b32 s73, 0
L_rl49:
    s_sleep 1
    s_mul_i32 s75, s70, 20480
    s_mul_i32 s74, s86, 28672
    s_add_u32 s75, s75, s74
    s_add_u32 s75, s75, 36864
    buffer_load_dwordx4 v[208:211], v6, s[20:23], s75 offen sc1
    buffer_load_dwordx4 v[212:215], v6, s[20:23], s75 offen offset:1024 sc1
    s_mul_i32 s75, s70, 20480
    s_mul_i32 s74, s87, 28672
    s_add_u32 s75, s75, s74
    s_add_u32 s75, s75, 36864
    buffer_load_dwordx4 v[216:219], v6, s[20:23], s75 offen sc1
    buffer_load_dwordx4 v[220:223], v6, s[20:23], s75 offen offset:1024 sc1
    s_waitcnt vmcnt(0)
    v_max3_u32 v254, v208, v211, v212
    v_max_u32 v254, v254, v215
    v_cmp_eq_u32 vcc, -1, v254
    s_cbranch_vccz L_back48
    s_add_u32 s73, s73, 1
    s_cmp_lt_u32 s73, 100000
    s_cbranch_scc1 L_rl49
    s_branch L_back48
L_retry50:
    s_mov_b32 s73, 0
L_rl52:
    s_sleep 1
    s_mul_i32 s75, s70, 20480
    s_mul_i32 s74, s87, 28672
    s_add_u32 s75, s75, s74
    s_add_u32 s75, s75, 36864
    buffer_load_dwordx4 v[216:219], v6, s[20:23], s75 offen sc1
    buffer_load_dwordx4 v[220:223], v6, s[20:23], s75 offen offset:1024 sc1
    s_mul_i32 s75, s70, 8192
    s_mul_i32 s74, s84, 28672
    s_add_u32 s75, s75, s74
    s_add_u32 s75, s75, 40960
    buffer_load_dwordx4 v[128:131], v6, s[20:23], s75 offen sc1
    buffer_load_dwordx4 v[132:135], v6, s[20:23], s75 offen offset:1024 sc1
    s_mul_i32 s75, s70, 8192
    s_mul_i32 s74, s85, 28672
    s_add_u32 s75, s75, s74
    s_add_u32 s75, s75, 40960
    buffer_load_dwordx4 v[136:139], v6, s[20:23], s75 offen sc1
    buffer_load_dwordx4 v[140:143], v6, s[20:23], s75 offen offset:1024 sc1
    s_waitcnt vmcnt(0)
    v_max3_u32 v254, v216, v219, v220
    v_max_u32 v254, v254, v223
    v_cmp_eq_u32 vcc, -1, v254
    s_cbranch_vccz L_back51
    s_add_u32 s73, s73, 1
    s_cmp_lt_u32 s73, 100000
    s_cbranch_scc1 L_rl52
    s_branch L_back51
L_retry53:
    s_mov_b32 s73, 0
L_rl55:
    s_sleep 1
    s_mul_i32 s75, s70, 8192
    s_mul_i32 s74, s84, 28672
    s_add_u32 s75, s75, s74
    s_add_u32 s75, s75, 40960
    buffer_load_dwordx4 v[128:131], v6, s[20:23], s75 offen sc1
    buffer_load_dwordx4 v[132:135], v6, s[20:23], s75 offen offset:1024 sc1
    s_mul_i32 s75, s70, 8192
    s_mul_i32 s74, s85, 28672
    s_add_u32 s75, s75, s74
    s_add_u32 s75, s75, 40960
    buffer_load_dwordx4 v[136:139], v6, s[20:23], s75 offen sc1
    buffer_load_dwordx4 v[140:143], v6, s[20:23], s75 offen offset:1024 sc1
    s_mul_i32 s75, s70, 8192
    s_mul_i32 s74, s86, 28672
    s_add_u32 s75, s75, s74
    s_add_u32 s75, s75, 40960
    buffer_load_dwordx4 v[144:147], v6, s[20:23], s75 offen sc1
    buffer_load_dwordx4 v[148:151], v6, s[20:23], s75 offen offset:1024 sc1
    s_mul_i32 s75, s70, 8192
    s_mul_i32 s74, s87, 28672
    s_add_u32 s75, s75, s74
    s_add_u32 s75, s75, 40960
    buffer_load_dwordx4 v[152:155], v6, s[20:23], s75 offen sc1
    buffer_load_dwordx4 v[156:159], v6, s[20:23], s75 offen offset:1024 sc1
    s_waitcnt vmcnt(0)
    v_max3_u32 v254, v128, v131, v132
    v_max_u32 v254, v254, v135
    v_cmp_eq_u32 vcc, -1, v254
    s_cbranch_vccz L_back54
    s_add_u32 s73, s73, 1
    s_cmp_lt_u32 s73, 100000
    s_cbranch_scc1 L_rl55
    s_branch L_back54
L_retry56:
    s_mov_b32 s73, 0
L_rl58:
    s_sleep 1
    s_mul_i32 s75, s70, 8192
    s_mul_i32 s74, s85, 28672
    s_add_u32 s75, s75, s74
    s_add_u32 s75, s75, 40960
    buffer_load_dwordx4 v[136:139], v6, s[20:23], s75 offen sc1
    buffer_load_dwordx4 v[140:143], v6, s[20:23], s75 offen offset:1024 sc1
    s_mul_i32 s75, s70, 8192
    s_mul_i32 s74, s86, 28672
    s_add_u32 s75, s75, s74
    s_add_u32 s75, s75, 40960
    buffer_load_dwordx4 v[144:147], v6, s[20:23], s75 offen sc1
    buffer_load_dwordx4 v[148:151], v6, s[20:23], s75 offen offset:1024 sc1
    s_mul_i32 s75, s70, 8192
    s_mul_i32 s74, s87, 28672
    s_add_u32 s75, s75, s74
    s_add_u32 s75, s75, 40960
    buffer_load_dwordx4 v[152:155], v6, s[20:23], s75 offen sc1
    buffer_load_dwordx4 v[156:159], v6, s[20:23], s75 offen offset:1024 sc1
    s_mul_i32 s75, s70, 28672
    s_mul_i32 s74, s64, 57344
    s_add_u32 s75, s75, s74
    s_add_u32 s75, s75, 45056
    buffer_load_dwordx4 v[192:195], v6, s[20:23], s75 offen sc1
    buffer_load_dwordx4 v[196:199], v6, s[20:23], s75 offen offset:1024 sc1
    s_mul_i32 s75, s70, 28672
    s_mul_i32 s74, s65, 57344
    s_add_u32 s75, s75, s74
    s_add_u32 s75, s75, 45056
    buffer_load_dwordx4 v[200:203], v6, s[20:23], s75 offen sc1
    buffer_load_dwordx4 v[204:207], v6, s[20:23], s75 offen offset:1024 sc1
    s_waitcnt vmcnt(0)
    v_max3_u32 v254, v136, v139, v140
    v_max_u32 v254, v254, v143
    v_cmp_eq_u32 vcc, -1, v254
    s_cbranch_vccz L_back57
    s_add_u32 s73, s73, 1
    s_cmp_lt_u32 s73, 100000
    s_cbranch_scc1 L_rl58
    s_branch L_back57
L_retry59:
    s_mov_b32 s73, 0
L_rl61:
    s_sleep 1
    s_mul_i32 s75, s70, 8192
    s_mul_i32 s74, s86, 28672
    s_add_u32 s75, s75, s74
    s_add_u32 s75, s75, 40960
    buffer_load_dwordx4 v[144:147], v6, s[20:23], s75 offen sc1
    buffer_load_dwordx4 v[148:151], v6, s[20:23], s75 offen offset:1024 sc1
    s_mul_i32 s75, s70, 8192
    s_mul_i32 s74, s87, 28672
    s_add_u32 s75, s75, s74
    s_add_u32 s75, s75, 40960
    buffer_load_dwordx4 v[152:155], v6, s[20:23], s75 offen sc1
    buffer_load_dwordx4 v[156:159], v6, s[20:23], s75 offen offset:1024 sc1
    s_mul_i32 s75, s70, 28672
    s_mul_i32 s74, s64, 57344
    s_add_u32 s75, s75, s74
    s_add_u32 s75, s75, 45056
    buffer_load_dwordx4 v[192:195], v6, s[20:23], s75 offen sc1
    buffer_load_dwordx4 v[196:199], v6, s[20:23], s75 offen offset:1024 sc1
    s_mul_i32 s75, s70, 28672
    s_mul_i32 s74, s65, 57344
    s_add_u32 s75, s75, s74
    s_add_u32 s75, s75, 45056
    buffer_load_dwordx4 v[200:203], v6, s[20:23], s75 offen sc1
    buffer_load_dwordx4 v[204:207], v6, s[20:23], s75 offen offset:1024 sc1
    s_waitcnt vmcnt(0)
    v_max3_u32 v254, v144, v147, v148
    v_max_u32 v254, v254, v151
    v_cmp_eq_u32 vcc, -1, v254
    s_cbranch_vccz L_back60
    s_add_u32 s73, s73, 1
    s_cmp_lt_u32 s73, 100000
    s_cbranch_scc1 L_rl61
    s_branch L_back60
L_retry62:
    s_mov_b32 s73, 0
L_rl64:
    s_sleep 1
    s_mul_i32 s75, s70, 8192
    s_mul_i32 s74, s87, 28672
    s_add_u32 s75, s75, s74
    s_add_u32 s75, s75, 40960
    buffer_load_dwordx4 v[152:155], v6, s[20:23], s75 offen sc1
    buffer_load_dwordx4 v[156:159], v6, s[20:23], s75 offen offset:1024 sc1
    s_mul_i32 s75, s70, 28672
    s_mul_i32 s74, s64, 57344
    s_add_u32 s75, s75, s74
    s_add_u32 s75, s75, 45056
    buffer_load_dwordx4 v[192:195], v6, s[20:23], s75 offen sc1
    buffer_load_dwordx4 v[196:199], v6, s[20:23], s75 offen offset:1024 sc1
    s_mul_i32 s75, s70, 28672
    s_mul_i32 s74, s65, 57344
    s_add_u32 s75, s75, s74
    s_add_u32 s75, s75, 45056
    buffer_load_dwordx4 v[200:203], v6, s[20:23], s75 offen sc1
    buffer_load_dwordx4 v[204:207], v6, s[20:23], s75 offen offset:1024 sc1
    s_waitcnt vmcnt(0)
    v_max3_u32 v254, v152, v155, v156
    v_max_u32 v254, v254, v159
    v_cmp_eq_u32 vcc, -1, v254
    s_cbranch_vccz L_back63
    s_add_u32 s73, s73, 1
    s_cmp_lt_u32 s73, 100000
    s_cbranch_scc1 L_rl64
    s_branch L_back63
L_retry65:
    s_mov_b32 s73, 0
L_rl67:
    s_sleep 1
    s_mul_i32 s75, s70, 28672
    s_mul_i32 s74, s64, 57344
    s_add_u32 s75, s75, s74
    s_add_u32 s75, s75, 45056
    buffer_load_dwordx4 v[192:195], v6, s[20:23], s75 offen sc1
    buffer_load_dwordx4 v[196:199], v6, s[20:23], s75 offen offset:1024 sc1
    s_mul_i32 s75, s70, 28672
    s_mul_i32 s74, s65, 57344
    s_add_u32 s75, s75, s74
    s_add_u32 s75, s75, 45056
    buffer_load_dwordx4 v[200:203], v6, s[20:23], s75 offen sc1
    buffer_load_dwordx4 v[204:207], v6, s[20:23], s75 offen offset:1024 sc1
    s_waitcnt vmcnt(0)
    v_max3_u32 v254, v192, v195, v196
    v_max_u32 v254, v254, v199
    v_cmp_eq_u32 vcc, -1, v254
    s_cbranch_vccz L_back66
    s_add_u32 s73, s73, 1
    s_cmp_lt_u32 s73, 100000
    s_cbranch_scc1 L_rl67
    s_branch L_back66
L_retry68:
    s_mov_b32 s73, 0
L_rl70:
    s_sleep 1
    s_mul_i32 s75, s70, 28672
    s_mul_i32 s74, s65, 57344
    s_add_u32 s75, s75, s74
    s_add_u32 s75, s75, 45056
    buffer_load_dwordx4 v[200:203], v6, s[20:23], s75 offen sc1
    buffer_load_dwordx4 v[204:207], v6, s[20:23], s75 offen offset:1024 sc1
    s_mul_i32 s75, s70, 4096
    s_mul_i32 s74, s84, 8192
    s_add_u32 s75, s75, s74
    buffer_load_dwordx4 v[208:211], v6, s[20:23], s75 offen sc1
    buffer_load_dwordx4 v[212:215], v6, s[20:23], s75 offen offset:1024 sc1
    s_mul_i32 s75, s70, 4096
    s_mul_i32 s74, s85, 8192
    s_add_u32 s75, s75, s74
    buffer_load_dwordx4 v[216:219], v6, s[20:23], s75 offen sc1
    s_waitcnt vmcnt(0)
    v_max3_u32 v254, v200, v203, v204
    v_max_u32 v254, v254, v207
    v_cmp_eq_u32 vcc, -1, v254
    s_cbranch_vccz L_back69
    s_add_u32 s73, s73, 1
    s_cmp_lt_u32 s73, 100000
    s_cbranch_scc1 L_rl70
    s_branch L_back69
L_retry71:
    s_mov_b32 s73, 0
L_rl73:
    s_sleep 1
    s_mul_i32 s75, s70, 4096
    s_mul_i32 s74, s84, 8192
    s_add_u32 s75, s75, s74
    buffer_load_dwordx4 v[208:211], v6, s[20:23], s75 offen sc1
    buffer_load_dwordx4 v[212:215], v6, s[20:23], s75 offen offset:1024 sc1
    s_mul_i32 s75, s70, 4096
    s_mul_i32 s74, s85, 8192
    s_add_u32 s75, s75, s74
    buffer_load_dwordx4 v[216:219], v6, s[20:23], s75 offen sc1
    buffer_load_dwordx4 v[220:223], v6, s[20:23], s75 offen offset:1024 sc1
    s_mul_i32 s75, s70, 4096
    s_mul_i32 s74, s86, 8192
    s_add_u32 s75, s75, s74
    buffer_load_dwordx4 v[128:131], v6, s[20:23], s75 offen sc1
    buffer_load_dwordx4 v[132:135], v6, s[20:23], s75 offen offset:1024 sc1
    s_mul_i32 s75, s70, 4096
    s_mul_i32 s74, s87, 8192
    s_add_u32 s75, s75, s74
    buffer_load_dwordx4 v[136:139], v6, s[20:23], s75 offen sc1
    s_waitcnt vmcnt(0)
    v_max3_u32 v254, v208, v211, v212
    v_max_u32 v254, v254, v215
    v_cmp_eq_u32 vcc, -1, v254
    s_cbranch_vccz L_back72
    s_add_u32 s73, s73, 1
    s_cmp_lt_u32 s73, 100000
    s_cbranch_scc1 L_rl73
    s_branch L_back72
L_retry74:
    s_mov_b32 s73, 0
L_rl76:
    s_sleep 1
    s_mul_i32 s75, s70, 4096
    s_mul_i32 s74, s85, 8192
    s_add_u32 s75, s75, s74
    buffer_load_dwordx4 v[216:219], v6, s[20:23], s75 offen sc1
    buffer_load_dwordx4 v[220:223], v6, s[20:23], s75 offen offset:1024 sc1
    s_mul_i32 s75, s70, 4096
    s_mul_i32 s74, s86, 8192
    s_add_u32 s75, s75, s74
    buffer_load_dwordx4 v[128:131], v6, s[20:23], s75 offen sc1
    buffer_load_dwordx4 v[132:135], v6, s[20:23], s75 offen offset:1024 sc1
    s_mul_i32 s75, s70, 4096
    s_mul_i32 s74, s87, 8192
    s_add_u32 s75, s75, s74
    buffer_load_dwordx4 v[136:139], v6, s[20:23], s75 offen sc1
    buffer_load_dwordx4 v[140:143], v6, s[20:23], s75 offen offset:1024 sc1
    s_waitcnt vmcnt(0)
    v_max3_u32 v254, v216, v219, v220
    v_max_u32 v254, v254, v223
    v_cmp_eq_u32 vcc, -1, v254
    s_cbranch_vccz L_back75
    s_add_u32 s73, s73, 1
    s_cmp_lt_u32 s73, 100000
    s_cbranch_scc1 L_rl76
    s_branch L_back75
L_retry77:
    s_mov_b32 s73, 0
L_rl79:
    s_sleep 1
    s_mul_i32 s75, s70, 4096
    s_mul_i32 s74, s86, 8192
    s_add_u32 s75, s75, s74
    buffer_load_dwordx4 v[128:131], v6, s[20:23], s75 offen sc1
    buffer_load_dwordx4 v[132:135], v6, s[20:23], s75 offen offset:1024 sc1
    s_mul_i32 s75, s70, 4096
    s_mul_i32 s74, s87, 8192
    s_add_u32 s75, s75, s74
    buffer_load_dwordx4 v[136:139], v6, s[20:23], s75 offen sc1
    buffer_load_dwordx4 v[140:143], v6, s[20:23], s75 offen offset:1024 sc1
    s_waitcnt vmcnt(0)
    v_max3_u32 v254, v128, v131, v132
    v_max3_u32 v254, v254, v135, v136
    v_max3_u32 v254, v254, v139, v140
    v_max_u32 v254, v254, v143
    v_cmp_eq_u32 vcc, -1, v254
    s_cbranch_vccz L_back78
    s_add_u32 s73, s73, 1
    s_cmp_lt_u32 s73, 100000
    s_cbranch_scc1 L_rl79
    s_branch L_back78
L_retry99:
    s_mov_b32 s73, 0
L_rl101:
    s_sleep 1
    buffer_load_dwordx4 v[224:227], v96, s[20:23], s77 offen sc1
    buffer_load_dwordx4 v[228:231], v96, s[20:23], s77 offen offset:1024 sc1
    buffer_load_dwordx4 v[232:235], v96, s[20:23], s77 offen offset:2048 sc1
    buffer_load_dwordx4 v[236:239], v96, s[20:23], s77 offen offset:3072 sc1
    s_waitcnt vmcnt(0)
    v_max3_u32 v98, v224, v226, v228
    v_max3_u32 v98, v98, v230, v232
    v_max3_u32 v98, v98, v234, v236
    v_max_u32 v98, v98, v238
    v_cmp_eq_u32 vcc, -1, v98
    s_cbranch_vccz L_back100
    s_add_u32 s73, s73, 1
    s_cmp_lt_u32 s73, 100000
    s_cbranch_scc1 L_rl101
    s_branch L_back100
L_retry102:
    s_mov_b32 s73, 0
L_rl104:
    s_sleep 1
    buffer_load_dword v5, v2, s[20:23], s79 offen sc1
    s_waitcnt vmcnt(0)
    v_cmp_eq_u32 vcc, -1, v5
    s_cbranch_vccz L_back103
    s_add_u32 s73, s73, 1
    s_cmp_lt_u32 s73, 100000
    s_cbranch_scc1 L_rl104
    s_branch L_back103
L_retry108:
    s_mov_b32 s73, 0
L_rl110:
    s_sleep 1
    s_mul_i32 s75, s70, 20480
    s_mul_i32 s74, s84, 28672
    s_add_u32 s75, s75, s74
    s_add_u32 s75, s75, 36864
    buffer_load_dwordx4 v[192:195], v6, s[20:23], s75 offen sc1
    buffer_load_dwordx4 v[196:199], v6, s[20:23], s75 offen offset:1024 sc1
    s_mul_i32 s75, s70, 20480
    s_mul_i32 s74, s85, 28672
    s_add_u32 s75, s75, s74
    s_add_u32 s75, s75, 36864
    buffer_load_dwordx4 v[200:203], v6, s[20:23], s75 offen sc1
    buffer_load_dwordx4 v[204:207], v6, s[20:23], s75 offen offset:1024 sc1
    s_mul_i32 s75, s70, 20480
    s_mul_i32 s74, s86, 28672
    s_add_u32 s75, s75, s74
    s_add_u32 s75, s75, 36864
    buffer_load_dwordx4 v[208:211], v6, s[20:23], s75 offen sc1
    buffer_load_dwordx4 v[212:215], v6, s[20:23], s75 offen offset:1024 sc1
    s_mul_i32 s75, s70, 20480
    s_mul_i32 s74, s87, 28672
    s_add_u32 s75, s75, s74
    s_add_u32 s75, s75, 36864
    buffer_load_dwordx4 v[216:219], v6, s[20:23], s75 offen sc1
    buffer_load_dwordx4 v[220:223], v6, s[20:23], s75 offen offset:1024 sc1
    s_waitcnt vmcnt(0)
    v_max3_u32 v254, v192, v195, v196
    v_max_u32 v254, v254, v199
    v_cmp_eq_u32 vcc, -1, v254
    s_cbranch_vccz L_back109
    s_add_u32 s73, s73, 1
    s_cmp_lt_u32 s73, 100000
    s_cbranch_scc1 L_rl110
    s_branch L_back109
L_retry111:
    s_mov_b32 s73, 0
L_rl113:
    s_sleep 1
    s_mul_i32 s75, s70, 20480
    s_mul_i32 s74, s85, 28672
    s_add_u32 s75, s75, s74
    s_add_u32 s75, s75, 36864
    buffer_load_dwordx4 v[200:203], v6, s[20:23], s75 offen sc1
    buffer_load_dwordx4 v[204:207], v6, s[20:23], s75 offen offset:1024 sc1
    s_mul_i32 s75, s70, 20480
    s_mul_i32 s74, s86, 28672
    s_add_u32 s75, s75, s74
    s_add_u32 s75, s75, 36864
    buffer_load_dwordx4 v[208:211], v6, s[20:23], s75 offen sc1
    buffer_load_dwordx4 v[212:215], v6, s[20:23], s75 offen offset:1024 sc1
    s_mul_i32 s75, s70, 20480
    s_mul_i32 s74, s87, 28672
    s_add_u32 s75, s75, s74
    s_add_u32 s75, s75, 36864
    buffer_load_dwordx4 v[216:219], v6, s[20:23], s75 offen sc1
    buffer_load_dwordx4 v[220:223], v6, s[20:23], s75 offen offset:1024 sc1
    s_waitcnt vmcnt(0)
    v_max3_u32 v254, v200, v203, v204
    v_max_u32 v254, v254, v207
    v_cmp_eq_u32 vcc, -1, v254
    s_cbranch_vccz L_back112
    s_add_u32 s73, s73, 1
    s_cmp_lt_u32 s73, 100000
    s_cbranch_scc1 L_rl113
    s_branch L_back112
L_retry114:
    s_mov_b32 s73, 0
L_rl116:
    s_sleep 1
    s_mul_i32 s75, s70, 20480
    s_mul_i32 s74, s86, 28672
    s_add_u32 s75, s75, s74
    s_add_u32 s75, s75, 36864
    buffer_load_dwordx4 v[208:211], v6, s[20:23], s75 offen sc1
    buffer_load_dwordx4 v[212:215], v6, s[20:23], s75 offen offset:1024 sc1
    s_mul_i32 s75, s70, 20480
    s_mul_i32 s74, s87, 28672
    s_add_u32 s75, s75, s74
    s_add_u32 s75, s75, 36864
    buffer_load_dwordx4 v[216:219], v6, s[20:23], s75 offen sc1
    buffer_load_dwordx4 v[220:223], v6, s[20:23], s75 offen offset:1024 sc1
    s_waitcnt vmcnt(0)
    v_max3_u32 v254, v208, v211, v212
    v_max_u32 v254, v254, v215
    v_cmp_eq_u32 vcc, -1, v254
    s_cbranch_vccz L_back115
    s_add_u32 s73, s73, 1
    s_cmp_lt_u32 s73, 100000
    s_cbranch_scc1 L_rl116
    s_branch L_back115
L_retry117:
    s_mov_b32 s73, 0
L_rl119:
    s_sleep 1
    s_mul_i32 s75, s70, 20480
    s_mul_i32 s74, s87, 28672
    s_add_u32 s75, s75, s74
    s_add_u32 s75, s75, 36864
    buffer_load_dwordx4 v[216:219], v6, s[20:23], s75 offen sc1
    buffer_load_dwordx4 v[220:223], v6, s[20:23], s75 offen offset:1024 sc1
    s_mul_i32 s75, s70, 8192
    s_mul_i32 s74, s84, 28672
    s_add_u32 s75, s75, s74
    s_add_u32 s75, s75, 40960
    buffer_load_dwordx4 v[128:131], v6, s[20:23], s75 offen sc1
    buffer_load_dwordx4 v[132:135], v6, s[20:23], s75 offen offset:1024 sc1
    s_mul_i32 s75, s70, 8192
    s_mul_i32 s74, s85, 28672
    s_add_u32 s75, s75, s74
    s_add_u32 s75, s75, 40960
    buffer_load_dwordx4 v[136:139], v6, s[20:23], s75 offen sc1
    buffer_load_dwordx4 v[140:143], v6, s[20:23], s75 offen offset:1024 sc1
    s_mul_i32 s75, s70, 8192
    s_mul_i32 s74, s86, 28672
    s_add_u32 s75, s75, s74
    s_add_u32 s75, s75, 40960
    buffer_load_dwordx4 v[144:147], v6, s[20:23], s75 offen sc1
    buffer_load_dwordx4 v[148:151], v6, s[20:23], s75 offen offset:1024 sc1
    s_waitcnt vmcnt(0)
    v_max3_u32 v254, v216, v219, v220
    v_max_u32 v254, v254, v223
    v_cmp_eq_u32 vcc, -1, v254
    s_cbranch_vccz L_back118
    s_add_u32 s73, s73, 1
    s_cmp_lt_u32 s73, 100000
    s_cbranch_scc1 L_rl119
    s_branch L_back118
L_retry120:
    s_mov_b32 s73, 0
L_rl122:
    s_sleep 1
    s_mul_i32 s75, s70, 8192
    s_mul_i32 s74, s84, 28672
    s_add_u32 s75, s75, s74
    s_add_u32 s75, s75, 40960
    buffer_load_dwordx4 v[128:131], v6, s[20:23], s75 offen sc1
    buffer_load_dwordx4 v[132:135], v6, s[20:23], s75 offen offset:1024 sc1
    s_mul_i32 s75, s70, 8192
    s_mul_i32 s74, s85, 28672
    s_add_u32 s75, s75, s74
    s_add_u32 s75, s75, 40960
    buffer_load_dwordx4 v[136:139], v6, s[20:23], s75 offen sc1
    buffer_load_dwordx4 v[140:143], v6, s[20:23], s75 offen offset:1024 sc1
    s_mul_i32 s75, s70, 8192
    s_mul_i32 s74, s86, 28672
    s_add_u32 s75, s75, s74
    s_add_u32 s75, s75, 40960
    buffer_load_dwordx4 v[144:147], v6, s[20:23], s75 offen sc1
    buffer_load_dwordx4 v[148:151], v6, s[20:23], s75 offen offset:1024 sc1
    s_mul_i32 s75, s70, 8192
    s_mul_i32 s74, s87, 28672
    s_add_u32 s75, s75, s74
    s_add_u32 s75, s75, 40960
    buffer_load_dwordx4 v[152:155], v6, s[20:23], s75 offen sc1
    buffer_load_dwordx4 v[156:159], v6, s[20:23], s75 offen offset:1024 sc1
    s_mul_i32 s75, s70, 28672
    s_mul_i32 s74, s64, 57344
    s_add_u32 s75, s75, s74
    s_add_u32 s75, s75, 45056
    buffer_load_dwordx4 v[192:195], v6, s[20:23], s75 offen sc1
    buffer_load_dwordx4 v[196:199], v6, s[20:23], s75 offen offset:1024 sc1
    s_waitcnt vmcnt(0)
    v_max3_u32 v254, v128, v131, v132
    v_max_u32 v254, v254, v135
    v_cmp_eq_u32 vcc, -1, v254
    s_cbranch_vccz L_back121
    s_add_u32 s73, s73, 1
    s_cmp_lt_u32 s73, 100000
    s_cbranch_scc1 L_rl122
    s_branch L_back121
L_retry123:
    s_mov_b32 s73, 0
L_rl125:
    s_sleep 1
    s_mul_i32 s75, s70, 8192
    s_mul_i32 s74, s85, 28672
    s_add_u32 s75, s75, s74
    s_add_u32 s75, s75, 40960
    buffer_load_dwordx4 v[136:139], v6, s[20:23], s75 offen sc1
    buffer_load_dwordx4 v[140:143], v6, s[20:23], s75 offen offset:1024 sc1
    s_mul_i32 s75, s70, 8192
    s_mul_i32 s74, s86, 28672
    s_add_u32 s75, s75, s74
    s_add_u32 s75, s75, 40960
    buffer_load_dwordx4 v[144:147], v6, s[20:23], s75 offen sc1
    buffer_load_dwordx4 v[148:151], v6, s[20:23], s75 offen offset:1024 sc1
    s_mul_i32 s75, s70, 8192
    s_mul_i32 s74, s87, 28672
    s_add_u32 s75, s75, s74
    s_add_u32 s75, s75, 40960
    buffer_load_dwordx4 v[152:155], v6, s[20:23], s75 offen sc1
    buffer_load_dwordx4 v[156:159], v6, s[20:23], s75 offen offset:1024 sc1
    s_mul_i32 s75, s70, 28672
    s_mul_i32 s74, s64, 57344
    s_add_u32 s75, s75, s74
    s_add_u32 s75, s75, 45056
    buffer_load_dwordx4 v[192:195], v6, s[20:23], s75 offen sc1
    buffer_load_dwordx4 v[196:199], v6, s[20:23], s75 offen offset:1024 sc1
    s_mul_i32 s75, s70, 28672
    s_mul_i32 s74, s65, 57344
    s_add_u32 s75, s75, s74
    s_add_u32 s75, s75, 45056
    buffer_load_dwordx4 v[200:203], v6, s[20:23], s75 offen sc1
    buffer_load_dwordx4 v[204:207], v6, s[20:23], s75 offen offset:1024 sc1
    s_waitcnt vmcnt(0)
    v_max3_u32 v254, v136, v139, v140
    v_max_u32 v254, v254, v143
    v_cmp_eq_u32 vcc, -1, v254
    s_cbranch_vccz L_back124
    s_add_u32 s73, s73, 1
    s_cmp_lt_u32 s73, 100000
    s_cbranch_scc1 L_rl125
    s_branch L_back124
L_retry126:
    s_mov_b32 s73, 0
L_rl128:
    s_sleep 1
    s_mul_i32 s75, s70, 8192
    s_mul_i32 s74, s86, 28672
    s_add_u32 s75, s75, s74
    s_add_u32 s75, s75, 40960
    buffer_load_dwordx4 v[144:147], v6, s[20:23], s75 offen sc1
    buffer_load_dwordx4 v[148:151], v6, s[20:23], s75 offen offset:1024 sc1
    s_mul_i32 s75, s70, 8192
    s_mul_i32 s74, s87, 28672
    s_add_u32 s75, s75, s74
    s_add_u32 s75, s75, 40960
    buffer_load_dwordx4 v[152:155], v6, s[20:23], s75 offen sc1
    buffer_load_dwordx4 v[156:159], v6, s[20:23], s75 offen offset:1024 sc1
    s_mul_i32 s75, s70, 28672
    s_mul_i32 s74, s64, 57344
    s_add_u32 s75, s75, s74
    s_add_u32 s75, s75, 45056
    buffer_load_dwordx4 v[192:195], v6, s[20:23], s75 offen sc1
    buffer_load_dwordx4 v[196:199], v6, s[20:23], s75 offen offset:1024 sc1
    s_mul_i32 s75, s70, 28672
    s_mul_i32 s74, s65, 57344
    s_add_u32 s75, s75, s74
    s_add_u32 s75, s75, 45056
    buffer_load_dwordx4 v[200:203], v6, s[20:23], s75 offen sc1
    buffer_load_dwordx4 v[204:207], v6, s[20:23], s75 offen offset:1024 sc1
    s_waitcnt vmcnt(0)
    v_max3_u32 v254, v144, v147, v148
    v_max_u32 v254, v254, v151
    v_cmp_eq_u32 vcc, -1, v254
    s_cbranch_vccz L_back127
    s_add_u32 s73, s73, 1
    s_cmp_lt_u32 s73, 100000
    s_cbranch_scc1 L_rl128
    s_branch L_back127
L_retry129:
    s_mov_b32 s73, 0
L_rl131:
    s_sleep 1
    s_mul_i32 s75, s70, 8192
    s_mul_i32 s74, s87, 28672
    s_add_u32 s75, s75, s74
    s_add_u32 s75, s75, 40960
    buffer_load_dwordx4 v[152:155], v6, s[20:23], s75 offen sc1
    buffer_load_dwordx4 v[156:159], v6, s[20:23], s75 offen offset:1024 sc1
    s_mul_i32 s75, s70, 28672
    s_mul_i32 s74, s64, 57344
    s_add_u32 s75, s75, s74
    s_add_u32 s75, s75, 45056
    buffer_load_dwordx4 v[192:195], v6, s[20:23], s75 offen sc1
    buffer_load_dwordx4 v[196:199], v6, s[20:23], s75 offen offset:1024 sc1
    s_mul_i32 s75, s70, 28672
    s_mul_i32 s74, s65, 57344
    s_add_u32 s75, s75, s74
    s_add_u32 s75, s75, 45056
    buffer_load_dwordx4 v[200:203], v6, s[20:23], s75 offen sc1
    buffer_load_dwordx4 v[204:207], v6, s[20:23], s75 offen offset:1024 sc1
    s_waitcnt vmcnt(0)
    v_max3_u32 v254, v152, v155, v156
    v_max_u32 v254, v254, v159
    v_cmp_eq_u32 vcc, -1, v254
    s_cbranch_vccz L_back130
    s_add_u32 s73, s73, 1
    s_cmp_lt_u32 s73, 100000
    s_cbranch_scc1 L_rl131
    s_branch L_back130
L_retry132:
    s_mov_b32 s73, 0
L_rl134:
    s_sleep 1
    s_mul_i32 s75, s70, 28672
    s_mul_i32 s74, s64, 57344
    s_add_u32 s75, s75, s74
    s_add_u32 s75, s75, 45056
    buffer_load_dwordx4 v[192:195], v6, s[20:23], s75 offen sc1
    buffer_load_dwordx4 v[196:199], v6, s[20:23], s75 offen offset:1024 sc1
    s_mul_i32 s75, s70, 28672
    s_mul_i32 s74, s65, 57344
    s_add_u32 s75, s75, s74
    s_add_u32 s75, s75, 45056
    buffer_load_dwordx4 v[200:203], v6, s[20:23], s75 offen sc1
    buffer_load_dwordx4 v[204:207], v6, s[20:23], s75 offen offset:1024 sc1
    s_waitcnt vmcnt(0)
    v_max3_u32 v254, v192, v195, v196
    v_max_u32 v254, v254, v199
    v_cmp_eq_u32 vcc, -1, v254
    s_cbranch_vccz L_back133
    s_add_u32 s73, s73, 1
    s_cmp_lt_u32 s73, 100000
    s_cbranch_scc1 L_rl134
    s_branch L_back133
L_retry135:
    s_mov_b32 s73, 0
L_rl137:
    s_sleep 1
    s_mul_i32 s75, s70, 28672
    s_mul_i32 s74, s65, 57344
    s_add_u32 s75, s75, s74
    s_add_u32 s75, s75, 45056
    buffer_load_dwordx4 v[200:203], v6, s[20:23], s75 offen sc1
    buffer_load_dwordx4 v[204:207], v6, s[20:23], s75 offen offset:1024 sc1
    s_mul_i32 s75, s70, 4096
    s_mul_i32 s74, s84, 8192
    s_add_u32 s75, s75, s74
    buffer_load_dwordx4 v[208:211], v6, s[20:23], s75 offen sc1
    buffer_load_dwordx4 v[212:215], v6, s[20:23], s75 offen offset:1024 sc1
    s_mul_i32 s75, s70, 4096
    s_mul_i32 s74, s85, 8192
    s_add_u32 s75, s75, s74
    buffer_load_dwordx4 v[216:219], v6, s[20:23], s75 offen sc1
    s_waitcnt vmcnt(0)
    v_max3_u32 v254, v200, v203, v204
    v_max_u32 v254, v254, v207
    v_cmp_eq_u32 vcc, -1, v254
    s_cbranch_vccz L_back136
    s_add_u32 s73, s73, 1
    s_cmp_lt_u32 s73, 100000
    s_cbranch_scc1 L_rl137
    s_branch L_back136
L_retry138:
    s_mov_b32 s73, 0
L_rl140:
    s_sleep 1
    s_mul_i32 s75, s70, 4096
    s_mul_i32 s74, s84, 8192
    s_add_u32 s75, s75, s74
    buffer_load_dwordx4 v[208:211], v6, s[20:23], s75 offen sc1
    buffer_load_dwordx4 v[212:215], v6, s[20:23], s75 offen offset:1024 sc1
    s_mul_i32 s75, s70, 4096
    s_mul_i32 s74, s85, 8192
    s_add_u32 s75, s75, s74
    buffer_load_dwordx4 v[216:219], v6, s[20:23], s75 offen sc1
    buffer_load_dwordx4 v[220:223], v6, s[20:23], s75 offen offset:1024 sc1
    s_mul_i32 s75, s70, 4096
    s_mul_i32 s74, s86, 8192
    s_add_u32 s75, s75, s74
    buffer_load_dwordx4 v[128:131], v6, s[20:23], s75 offen sc1
    buffer_load_dwordx4 v[132:135], v6, s[20:23], s75 offen offset:1024 sc1
    s_mul_i32 s75, s70, 4096
    s_mul_i32 s74, s87, 8192
    s_add_u32 s75, s75, s74
    buffer_load_dwordx4 v[136:139], v6, s[20:23], s75 offen sc1
    s_waitcnt vmcnt(0)
    v_max3_u32 v254, v208, v211, v212
    v_max_u32 v254, v254, v215
    v_cmp_eq_u32 vcc, -1, v254
    s_cbranch_vccz L_back139
    s_add_u32 s73, s73, 1
    s_cmp_lt_u32 s73, 100000
    s_cbranch_scc1 L_rl140
    s_branch L_back139
L_retry141:
    s_mov_b32 s73, 0
L_rl143:
    s_sleep 1
    s_mul_i32 s75, s70, 4096
    s_mul_i32 s74, s85, 8192
    s_add_u32 s75, s75, s74
    buffer_load_dwordx4 v[216:219], v6, s[20:23], s75 offen sc1
    buffer_load_dwordx4 v[220:223], v6, s[20:23], s75 offen offset:1024 sc1
    s_mul_i32 s75, s70, 4096
    s_mul_i32 s74, s86, 8192
    s_add_u32 s75, s75, s74
    buffer_load_dwordx4 v[128:131], v6, s[20:23], s75 offen sc1
    buffer_load_dwordx4 v[132:135], v6, s[20:23], s75 offen offset:1024 sc1
    s_mul_i32 s75, s70, 4096
    s_mul_i32 s74, s87, 8192
    s_add_u32 s75, s75, s74
    buffer_load_dwordx4 v[136:139], v6, s[20:23], s75 offen sc1
    buffer_load_dwordx4 v[140:143], v6, s[20:23], s75 offen offset:1024 sc1
    s_waitcnt vmcnt(0)
    v_max3_u32 v254, v216, v219, v220
    v_max_u32 v254, v254, v223
    v_cmp_eq_u32 vcc, -1, v254
    s_cbranch_vccz L_back142
    s_add_u32 s73, s73, 1
    s_cmp_lt_u32 s73, 100000
    s_cbranch_scc1 L_rl143
    s_branch L_back142
L_retry144:
    s_mov_b32 s73, 0
L_rl146:
    s_sleep 1
    s_mul_i32 s75, s70, 4096
    s_mul_i32 s74, s86, 8192
    s_add_u32 s75, s75, s74
    buffer_load_dwordx4 v[128:131], v6, s[20:23], s75 offen sc1
    buffer_load_dwordx4 v[132:135], v6, s[20:23], s75 offen offset:1024 sc1
    s_mul_i32 s75, s70, 4096
    s_mul_i32 s74, s87, 8192
    s_add_u32 s75, s75, s74
    buffer_load_dwordx4 v[136:139], v6, s[20:23], s75 offen sc1
    buffer_load_dwordx4 v[140:143], v6, s[20:23], s75 offen offset:1024 sc1
    s_waitcnt vmcnt(0)
    v_max3_u32 v254, v128, v131, v132
    v_max3_u32 v254, v254, v135, v136
    v_max3_u32 v254, v254, v139, v140
    v_max_u32 v254, v254, v143
    v_cmp_eq_u32 vcc, -1, v254
    s_cbranch_vccz L_back145
    s_add_u32 s73, s73, 1
    s_cmp_lt_u32 s73, 100000
    s_cbranch_scc1 L_rl146
    s_branch L_back145
.p2align 6
L_typeB:
    v_lshrrev_b32 v16, 5, v1
    v_bfe_u32 v17, v1, 4, 1
    v_bfe_u32 v18, v1, 2, 2
    v_and_b32 v19, 3, v1
    v_lshl_add_u32 v20, v16, 3, v18
    v_lshlrev_b32 v20, 7, v20
    v_lshl_add_u32 v20, v17, 13, v20
    v_lshrrev_b32 v21, 1, v18
    v_lshl_add_u32 v21, v17, 1, v21
    s_lshl_b32 s7, s58, 1
    v_xor_b32 v21, s7, v21
    v_lshl_add_u32 v20, v21, 5, v20
    v_lshl_add_u32 v44, v19, 3, v20
    s_mov_b32 s44, s80
    s_mov_b32 s45, s81
    s_mov_b32 s46, 0x380
    s_mov_b32 s47, 0x20000
    v_lshlrev_b32 v24, 4, v1
    s_mov_b32 s7, s32
    s_cmp_eq_u32 s3, 1
    s_cselect_b32 s7, s33, s7
    s_cmp_eq_u32 s3, 2
    s_cselect_b32 s7, s34, s7
    s_cmp_eq_u32 s3, 3
    s_cselect_b32 s7, s35, s7
    s_cmp_eq_u32 s3, 4
    s_cselect_b32 s7, s36, s7
    s_cmp_eq_u32 s3, 5
    s_cselect_b32 s7, s37, s7
    s_cmp_eq_u32 s3, 6
    s_cselect_b32 s7, s38, s7
    v_lshlrev_b32 v25, 1, v1
    v_mov_b32 v41, 0
    buffer_load_ushort v40, v25, s[44:47], s7 offen
    s_and_b32 s7, s3, 3
    s_lshl_b32 s7, s7, 10
    s_add_u32 m0, s7, 148480
    s_mul_i32 s51, s5, 3136
    s_add_u32 s7, s7, s51
    buffer_load_dwordx4 v24, s[28:31], s7 offen lds
    s_cmp_lg_u32 s58, 0
    s_cbranch_scc1 L_pr105
    s_setprio 1
L_pr105:
    s_waitcnt vmcnt(6)
    s_barrier
    v_or_b32 v3, 16384, v44
    v_xor_b32 v4, 16416, v44
    v_xor_b32 v5, 0, v2
    ds_read_b128 v[224:227], v5
    ds_read_b64_tr_b16 v[48:49], v3
    ds_read_b64_tr_b16 v[50:51], v3 offset:512
    ds_read_b64_tr_b16 v[52:53], v4
    ds_read_b64_tr_b16 v[54:55], v4 offset:512
    v_xor_b32 v5, 32, v2
    ds_read_b128 v[228:231], v5
    ds_read_b64_tr_b16 v[56:57], v3 offset:2048
    ds_read_b64_tr_b16 v[58:59], v3 offset:2560
    ds_read_b64_tr_b16 v[60:61], v4 offset:2048
    ds_read_b64_tr_b16 v[62:63], v4 offset:2560
    v_xor_b32 v5, 64, v2
    s_waitcnt lgkmcnt(7)
    v_mfma_f32_32x32x16_bf16 v[64:79], v[48:51], v[224:227], 0
    ds_read_b128 v[232:235], v5
    ds_read_b64_tr_b16 v[248:249], v3 offset:4096
    ds_read_b64_tr_b16 v[250:251], v3 offset:4608
    s_waitcnt lgkmcnt(8)
    s_add_u32 m0, s40, 65536
    s_nop 0
    buffer_load_dwordx4 v8, s[8:11], s33 offen lds
    s_mov_b32 s48, 0x3fb8aa3b
    s_mov_b32 s49, 0xbdd2d3e8
    v_mov_b32 v47, 0xc0135761
    s_mov_b32 s52, 0
    s_mov_b32 s53, -1
    s_mov_b32 s54, 0x10000000
    s_mov_b32 s55, 0x10000000
    s_and_b32 s7, s3, 3
    s_mul_i32 s51, s7, 147456
    v_lshlrev_b32 v7, 4, v1
    v_add_u32 v7, s51, v7
    s_mul_i32 s42, s4, 589824
    v_cndmask_b32_e64 v42, 1.0, 0, s[52:53]
    v_mfma_f32_32x32x16_bf16 v[80:95], v[52:55], v[224:227], 0
    ds_read_b64_tr_b16 v[48:49], v4 offset:4096
    ds_read_b64_tr_b16 v[50:51], v4 offset:4608
    s_waitcnt lgkmcnt(7)
    buffer_load_dwordx4 v9, s[8:11], s33 offen offset:1024 lds
    s_lshl_b32 s59, s56, 6
    s_add_u32 s59, s59, s42
    s_add_u32 s59, s59, 32768
    s_lshl_b32 s51, s58, 11
    s_add_u32 s59, s59, s51
    s_lshl_b32 s60, s57, 6
    s_add_u32 s60, s60, s42
    s_add_u32 s60, s60, 32768
    s_lshl_b32 s51, s58, 10
    v_xor_b32 v5, 96, v2
    v_mfma_f32_32x32x16_bf16 v[64:79], v[56:59], v[228:231], v[64:79]
    ds_read_b128 v[236:239], v5
    ds_read_b64_tr_b16 v[52:53], v3 offset:6144
    ds_read_b64_tr_b16 v[54:55], v3 offset:6656
    s_waitcnt lgkmcnt(8)
    s_add_u32 m0, s40, 81920
    s_mul_i32 s39, s33, 1792
    buffer_load_dwordx4 v12, s[16:19], s39 offen lds
    s_add_u32 s60, s60, s51
    s_lshr_b32 s7, s2, 3
    s_and_b32 s51, s7, 1
    s_lshr_b32 s43, s7, 2
    s_lshl_b32 s43, s43, 1
    s_add_u32 s51, s51, s43
    s_sub_u32 s43, s7, 4
    s_cmp_lt_u32 s7, 8
    s_cselect_b32 s43, s51, s43
    s_cselect_b32 s63, 1, 0
    s_waitcnt vmcnt(5)
    s_barrier
    v_mfma_f32_32x32x16_bf16 v[80:95], v[60:63], v[228:231], v[80:95]
    ds_read_b64_tr_b16 v[56:57], v4 offset:6144
    ds_read_b64_tr_b16 v[58:59], v4 offset:6656
    s_waitcnt lgkmcnt(7)
    buffer_load_dwordx4 v13, s[16:19], s39 offen offset:1024 lds
    s_cmp_eq_u32 s6, 0
    s_cselect_b32 s63, s63, 0
    s_mul_i32 s51, s43, 37
    s_lshr_b32 s51, s51, 8
    s_mul_i32 s62, s51, 7
    s_sub_u32 s62, s43, s62
    s_and_b32 s61, s2, 7
    s_lshl_b32 s61, s61, 2
    s_add_u32 s61, s61, s51
    v_or_b32 v3, 49152, v44
    v_xor_b32 v4, 49184, v44
    v_xor_b32 v5, 32768, v2
    v_mfma_f32_32x32x16_bf16 v[64:79], v[248:251], v[232:235], v[64:79]
    ds_read_b128 v[128:131], v5
    ds_read_b64_tr_b16 v[60:61], v3
    ds_read_b64_tr_b16 v[62:63], v3 offset:512
    s_waitcnt lgkmcnt(8)
    s_add_u32 m0, s40, 98304
    s_nop 0
    buffer_load_dwordx4 v8, s[8:11], s34 offen lds
    s_bfe_u32 s70, s3, 0x10001
    s_add_u32 s7, s61, s62
    s_add_u32 s84, s7, 0
    s_and_b32 s84, s84, 3
    s_add_u32 s85, s7, 1
    s_and_b32 s85, s85, 3
    s_add_u32 s86, s7, 2
    s_and_b32 s86, s86, 3
    s_add_u32 s87, s7, 3
    v_mfma_f32_32x32x16_bf16 v[80:95], v[48:51], v[232:235], v[80:95]
    ds_read_b64_tr_b16 v[248:249], v4
    ds_read_b64_tr_b16 v[250:251], v4 offset:512
    s_waitcnt lgkmcnt(7)
    buffer_load_dwordx4 v9, s[8:11], s34 offen offset:1024 lds
    s_and_b32 s87, s87, 3
    s_and_b32 s64, s7, 1
    s_xor_b32 s65, s64, 1
    s_lshl_b32 s66, s5, 18
    s_lshl_b32 s7, s4, 10
    s_add_u32 s66, s66, s7
    s_lshl_b32 s51, s3, 7
    s_add_u32 s66, s66, s51
    s_add_u32 s66, s66, 10485760
    v_xor_b32 v5, 32800, v2
    v_mfma_f32_32x32x16_bf16 v[64:79], v[52:55], v[236:239], v[64:79]
    ds_read_b128 v[132:135], v5
    ds_read_b64_tr_b16 v[48:49], v3 offset:2048
    ds_read_b64_tr_b16 v[50:51], v3 offset:2560
    s_waitcnt lgkmcnt(8)
    s_add_u32 m0, s40, 114688
    s_mul_i32 s39, s34, 1792
    buffer_load_dwordx4 v12, s[16:19], s39 offen lds
    s_lshl_b32 s67, s5, 13
    s_add_u32 s67, s67, 12582912
    s_lshl_b32 s7, s58, 12
    s_add_u32 s77, s67, s7
    s_add_u32 s67, s67, s51
    s_lshr_b32 s7, s4, 1
    s_lshl_b32 s7, s7, 10
    s_add_u32 s67, s67, s7
    s_and_b32 s7, s4, 1
    v_mfma_f32_32x32x16_bf16 v[80:95], v[56:59], v[236:239], v[80:95]
    ds_read_b64_tr_b16 v[52:53], v4 offset:2048
    ds_read_b64_tr_b16 v[54:55], v4 offset:2560
    s_waitcnt lgkmcnt(7)
    buffer_load_dwordx4 v13, s[16:19], s39 offen offset:1024 lds
    s_lshl_b32 s7, s7, 3
    s_add_u32 s67, s67, s7
    s_lshl_b32 s68, s5, 12
    s_lshl_b32 s7, s58, 11
    s_add_u32 s68, s68, s7
    s_add_u32 s68, s68, s42
    s_lshl_b32 s76, s4, 9
    s_and_b32 s7, s3, 3
    s_lshl_b32 s7, s7, 7
    v_xor_b32 v5, 32832, v2
    v_mfma_f32_32x32x16_bf16 v[64:79], v[60:63], v[128:131], v[64:79]
    ds_read_b128 v[136:139], v5
    ds_read_b64_tr_b16 v[56:57], v3 offset:4096
    ds_read_b64_tr_b16 v[58:59], v3 offset:4608
    s_waitcnt lgkmcnt(8)
    s_add_u32 m0, s40, 131072
    s_nop 0
    buffer_load_dwordx4 v8, s[8:11], s35 offen lds
    s_add_u32 s76, s76, s7
    s_add_u32 s76, s76, 13697024
    s_lshl_b32 s79, s61, 8
    s_lshl_b32 s7, s58, 7
    s_add_u32 s79, s79, s7
    s_add_u32 s79, s79, 13697024
    s_and_b32 s7, s4, 3
    s_lshl_b32 s51, s58, 2
    s_or_b32 s7, s7, s51
    v_mfma_f32_32x32x16_bf16 v[80:95], v[248:251], v[128:131], v[80:95]
    ds_read_b64_tr_b16 v[60:61], v4 offset:4096
    ds_read_b64_tr_b16 v[62:63], v4 offset:4608
    s_waitcnt lgkmcnt(7)
    buffer_load_dwordx4 v9, s[8:11], s35 offen offset:1024 lds
    s_cmp_eq_u32 s7, 7
    s_cselect_b32 s78, 0, -1
    v_mov_b32 v252, -1
    v_mov_b32 v253, -1
    v_mov_b32 v254, -1
    v_mov_b32 v255, -1
    s_lshl_b32 s80, s4, 7
    s_add_u32 s80, s80, 13631488
    s_lshr_b32 s81, s61, 1
    s_lshl_b32 s81, s81, 7
    s_add_u32 s81, s81, 13631488
    s_lshl_b32 s82, s5, 7
    s_add_u32 s82, s82, 13633536
    v_xor_b32 v5, 32864, v2
    v_mfma_f32_32x32x16_bf16 v[64:79], v[48:51], v[132:135], v[64:79]
    ds_read_b128 v[140:143], v5
    ds_read_b64_tr_b16 v[248:249], v3 offset:6144
    ds_read_b64_tr_b16 v[250:251], v3 offset:6656
    s_waitcnt lgkmcnt(8)
    s_lshl_b32 s7, s61, 1
    s_add_u32 s7, s7, s58
    s_mul_i32 s7, s7, 147456
    s_and_b32 s51, s3, 1
    s_lshl_b32 s51, s51, 11
    s_add_u32 s7, s7, s51
    s_lshl_b32 s51, s63, 30
    s_lshl_b32 s51, s51, 0
    s_add_u32 s7, s7, s51
    v_lshlrev_b32 v6, 4, v1
    v_add_u32 v6, s7, v6
    v_lshrrev_b32 v16, 5, v1
    v_bfe_u32 v17, v1, 4, 1
    v_bfe_u32 v18, v1, 2, 2
    s_waitcnt vmcnt(10)
    s_waitcnt vmcnt(6)
    s_barrier
    v_mfma_f32_32x32x16_bf16 v[80:95], v[52:55], v[132:135], v[80:95]
    ds_read_b64_tr_b16 v[48:49], v4 offset:6144
    ds_read_b64_tr_b16 v[50:51], v4 offset:6656
    s_waitcnt lgkmcnt(7)
    s_add_u32 m0, s40, 0
    s_mul_i32 s39, s35, 1792
    buffer_load_dwordx4 v12, s[16:19], s39 offen lds
    v_and_b32 v19, 3, v1
    v_lshl_add_u32 v20, v16, 2, v18
    v_or_b32 v3, 81920, v44
    v_xor_b32 v4, 81952, v44
    v_xor_b32 v5, 65536, v2
    v_mfma_f32_32x32x16_bf16 v[64:79], v[56:59], v[136:139], v[64:79]
    ds_read_b128 v[144:147], v5
    ds_read_b64_tr_b16 v[52:53], v3
    ds_read_b64_tr_b16 v[54:55], v3 offset:512
    s_waitcnt lgkmcnt(8)
    buffer_load_dwordx4 v13, s[16:19], s39 offen offset:1024 lds
    v_lshlrev_b32 v20, 7, v20
    v_lshrrev_b32 v21, 1, v18
    v_lshl_add_u32 v20, v21, 6, v20
    v_lshl_add_u32 v21, v17, 2, v19
    v_lshl_add_u32 v20, v21, 3, v20
    s_and_b32 s7, s3, 3
    s_lshl_b32 s7, s7, 12
    v_mfma_f32_32x32x16_bf16 v[80:95], v[60:63], v[136:139], v[80:95]
    ds_read_b64_tr_b16 v[56:57], v4
    ds_read_b64_tr_b16 v[58:59], v4 offset:512
    s_waitcnt lgkmcnt(7)
    s_add_u32 m0, s40, 16384
    s_nop 0
    buffer_load_dwordx4 v8, s[8:11], s36 offen lds
    v_add_u32 v14, s7, v20
    v_lshrrev_b32 v16, 3, v1
    s_lshl_b32 s7, s3, 3
    v_add_u32 v16, s7, v16
    v_mul_u32_u24 v16, 2688, v16
    v_xor_b32 v5, 65568, v2
    v_mfma_f32_32x32x16_bf16 v[64:79], v[248:251], v[140:143], v[64:79]
    ds_read_b128 v[148:151], v5
    ds_read_b64_tr_b16 v[60:61], v3 offset:2048
    ds_read_b64_tr_b16 v[62:63], v3 offset:2560
    s_waitcnt lgkmcnt(8)
    buffer_load_dwordx4 v9, s[8:11], s36 offen offset:1024 lds
    v_bfe_u32 v17, v1, 4, 1
    v_lshlrev_b32 v17, 2, v17
    v_and_b32 v18, 7, v1
    v_xor_b32 v17, v17, v18
    v_min_u32 v17, 6, v17
    v_mfma_f32_32x32x16_bf16 v[80:95], v[48:51], v[140:143], v[80:95]
    ds_read_b64_tr_b16 v[248:249], v4 offset:2048
    ds_read_b64_tr_b16 v[250:251], v4 offset:2560
    s_waitcnt lgkmcnt(7)
    v_lshl_add_u32 v16, v17, 4, v16
    s_mul_i32 s7, s5, 112
    v_add_u32 v43, s7, v16
    v_lshrrev_b32 v16, 5, v1
    v_bfe_u32 v17, v1, 4, 1
    v_xor_b32 v5, 65600, v2
    v_mfma_f32_32x32x16_bf16 v[64:79], v[52:55], v[144:147], v[64:79]
    ds_read_b128 v[152:155], v5
    ds_read_b64_tr_b16 v[48:49], v3 offset:4096
    ds_read_b64_tr_b16 v[50:51], v3 offset:4608
    s_waitcnt lgkmcnt(8)
    v_bfe_u32 v18, v1, 2, 2
    v_and_b32 v19, 3, v1
    v_lshl_add_u32 v20, v16, 3, v18
    v_lshlrev_b32 v20, 7, v20
    v_lshl_add_u32 v19, v17, 2, v19
    v_mfma_f32_32x32x16_bf16 v[80:95], v[56:59], v[144:147], v[80:95]
    ds_read_b64_tr_b16 v[52:53], v4 offset:4096
    ds_read_b64_tr_b16 v[54:55], v4 offset:4608
    s_waitcnt lgkmcnt(7)
    v_lshlrev_b32 v21, 3, v19
    s_mul_i32 s7, s58, 56
    v_add_u32 v21, s7, v21
    v_cmp_eq_u32 vcc, 7, v19
    v_lshl_add_u32 v19, v16, 2, v18
    v_xor_b32 v5, 65632, v2
    v_mfma_f32_32x32x16_bf16 v[64:79], v[60:63], v[148:151], v[64:79]
    ds_read_b128 v[156:159], v5
    ds_read_b64_tr_b16 v[56:57], v3 offset:6144
    ds_read_b64_tr_b16 v[58:59], v3 offset:6656
    s_waitcnt lgkmcnt(8)
    v_lshlrev_b32 v19, 3, v19
    v_add_u32 v19, 147456, v19
    v_lshrrev_b32 v18, 1, v18
    v_lshlrev_b32 v18, 6, v18
    v_xor_b32 v21, v21, v18
    s_waitcnt vmcnt(6)
    s_barrier
    v_mfma_f32_32x32x16_bf16 v[80:95], v[248:251], v[148:151], v[80:95]
    ds_read_b64_tr_b16 v[60:61], v4 offset:6144
    ds_read_b64_tr_b16 v[62:63], v4 offset:6656
    s_waitcnt lgkmcnt(7)
    s_add_u32 m0, s40, 32768
    s_mul_i32 s39, s36, 1792
    buffer_load_dwordx4 v12, s[16:19], s39 offen lds
    v_add_u32 v46, v20, v21
    v_cndmask_b32 v46, v46, v19
    v_or_b32 v3, 114688, v44
    v_xor_b32 v4, 114720, v44
    v_xor_b32 v5, 98304, v2
    v_mfma_f32_32x32x16_bf16 v[64:79], v[48:51], v[152:155], v[64:79]
    ds_read_b128 v[160:163], v5
    ds_read_b64_tr_b16 v[248:249], v3
    ds_read_b64_tr_b16 v[250:251], v3 offset:512
    s_waitcnt lgkmcnt(8)
    buffer_load_dwordx4 v13, s[16:19], s39 offen offset:1024 lds
    v_mov_b32 v20, 0xffffc000
    v_mov_b32 v21, 0xc0
    v_cndmask_b32 v45, v20, v21
    v_mfma_f32_32x32x16_bf16 v[80:95], v[52:55], v[152:155], v[80:95]
    ds_read_b64_tr_b16 v[48:49], v4
    ds_read_b64_tr_b16 v[50:51], v4 offset:512
    s_waitcnt lgkmcnt(7)
    s_add_u32 m0, s40, 49152
    s_nop 0
    buffer_load_dwordx4 v8, s[8:11], s37 offen lds
    v_lshrrev_b32 v16, 5, v1
    v_bfe_u32 v17, v1, 4, 1
    v_bfe_u32 v18, v1, 2, 2
    v_xor_b32 v5, 98336, v2
    v_mov_b32 v32, -1
    v_mov_b32 v33, -1
    v_mov_b32 v34, -1
    v_mov_b32 v35, -1
    buffer_store_dwordx4 v[32:35], v7, s[20:23], s68 offen sc1
    v_mfma_f32_32x32x16_bf16 v[64:79], v[56:59], v[156:159], v[64:79]
    ds_read_b128 v[164:167], v5
    ds_read_b64_tr_b16 v[52:53], v3 offset:2048
    ds_read_b64_tr_b16 v[54:55], v3 offset:2560
    s_waitcnt lgkmcnt(8)
    buffer_load_dwordx4 v9, s[8:11], s37 offen offset:1024 lds
    v_and_b32 v19, 3, v1
    v_lshl_add_u32 v20, v16, 2, v18
    v_mul_u32_u24 v20, 56, v20
    v_lshl_add_u32 v21, v17, 2, v19
    v_mfma_f32_32x32x16_bf16 v[80:95], v[60:63], v[156:159], v[80:95]
    ds_read_b64_tr_b16 v[56:57], v4 offset:2048
    ds_read_b64_tr_b16 v[58:59], v4 offset:2560
    s_waitcnt lgkmcnt(7)
    v_min_u32 v21, 6, v21
    v_lshl_add_u32 v20, v21, 3, v20
    s_mul_i32 s71, s58, 1568
    s_add_u32 s71, s71, 148480
    v_add_u32 v20, s71, v20
    v_xor_b32 v5, 98368, v2
    v_mfma_f32_32x32x16_bf16 v[64:79], v[248:251], v[160:163], v[64:79]
    ds_read_b128 v[168:171], v5
    ds_read_b64_tr_b16 v[60:61], v3 offset:4096
    ds_read_b64_tr_b16 v[62:63], v3 offset:4608
    s_waitcnt lgkmcnt(8)
    ds_read_b64_tr_b16 v[240:241], v20
    ds_read_b64_tr_b16 v[242:243], v20 offset:448
    ds_read_b64_tr_b16 v[244:245], v20 offset:896
    ds_read_b64_tr_b16 v[246:247], v20 offset:1344
    v_mov_b32 v21, 0
    v_mfma_f32_32x32x16_bf16 v[80:95], v[48:51], v[160:163], v[80:95]
    ds_read_b64_tr_b16 v[248:249], v4 offset:4096
    ds_read_b64_tr_b16 v[250:251], v4 offset:4608
    s_waitcnt lgkmcnt(11)
    v_xor_b32 v5, 98400, v2
    v_mfma_f32_32x32x16_bf16 v[64:79], v[52:55], v[164:167], v[64:79]
    ds_read_b128 v[172:175], v5
    ds_read_b64_tr_b16 v[48:49], v3 offset:6144
    ds_read_b64_tr_b16 v[50:51], v3 offset:6656
    s_waitcnt lgkmcnt(12)
    s_waitcnt lgkmcnt(5)
    v_cndmask_b32_e64 v246, v246, v21, s[52:53]
    v_cndmask_b32_e64 v247, v247, v21, s[52:53]
    s_waitcnt vmcnt(7)
    s_barrier
    v_mfma_f32_32x32x16_bf16 v[80:95], v[56:59], v[164:167], v[80:95]
    ds_read_b64_tr_b16 v[52:53], v4 offset:6144
    ds_read_b64_tr_b16 v[54:55], v4 offset:6656
    s_add_u32 m0, s40, 65536
    s_mul_i32 s39, s37, 1792
    buffer_load_dwordx4 v12, s[16:19], s39 offen lds
    v_or_b32 v3, 0, v44
    v_xor_b32 v4, 32, v44
    v_xor_b32 v5, 131072, v2
    v_mfma_f32_32x32x16_bf16 v[64:79], v[60:63], v[168:171], v[64:79]
    ds_read_b128 v[176:179], v5
    ds_read_b64_tr_b16 v[56:57], v3
    ds_read_b64_tr_b16 v[58:59], v3 offset:512
    s_waitcnt lgkmcnt(8)
    v_lshrrev_b32 v16, 4, v1
    v_lshlrev_b32 v16, 11, v16
    v_bfe_u32 v17, v1, 2, 1
    v_mfma_f32_32x32x16_bf16 v[80:95], v[248:251], v[168:171], v[80:95]
    ds_read_b64_tr_b16 v[60:61], v4
    ds_read_b64_tr_b16 v[62:63], v4 offset:512
    s_waitcnt lgkmcnt(7)
    buffer_load_dwordx4 v13, s[16:19], s39 offen offset:1024 lds
    v_lshl_add_u32 v16, v17, 9, v16
    v_bfe_u32 v17, v1, 3, 1
    v_xor_b32 v5, 131104, v2
    buffer_store_dwordx4 v[32:35], v7, s[20:23], s68 offen offset:1024 sc1
    v_mfma_f32_32x32x16_bf16 v[64:79], v[48:51], v[172:175], v[64:79]
    ds_read_b128 v[180:183], v5
    ds_read_b64_tr_b16 v[248:249], v3 offset:2048
    ds_read_b64_tr_b16 v[250:251], v3 offset:2560
    s_waitcnt lgkmcnt(8)
    v_lshl_add_u32 v16, v17, 5, v16
    v_and_b32 v17, 3, v1
    v_lshl_add_u32 v16, v17, 3, v16
    s_and_b32 s71, s3, 1
    s_lshl_b32 s71, s71, 13
    s_lshr_b32 s72, s3, 1
    s_lshl_b32 s72, s72, 6
    s_add_u32 s71, s71, s72
    s_add_u32 s71, s71, 147456
    v_mfma_f32_32x32x16_bf16 v[80:95], v[52:55], v[172:175], v[80:95]
    ds_read_b64_tr_b16 v[48:49], v4 offset:2048
    ds_read_b64_tr_b16 v[50:51], v4 offset:2560
    s_waitcnt lgkmcnt(7)
    s_add_u32 m0, s40, 81920
    s_mul_i32 s39, s32, 1792
    s_add_u32 s39, s39, 128
    buffer_load_dwordx4 v12, s[16:19], s39 offen lds
    v_add_u32 v16, s71, v16
    ds_write_b64 v16, v[40:41]
    v_xor_b32 v5, 131136, v2
    v_mfma_f32_32x32x16_bf16 v[64:79], v[56:59], v[176:179], v[64:79]
    ds_read_b128 v[184:187], v5
    ds_read_b64_tr_b16 v[52:53], v3 offset:4096
    ds_read_b64_tr_b16 v[54:55], v3 offset:4608
    s_waitcnt lgkmcnt(9)
    v_mfma_f32_32x32x16_bf16 v[80:95], v[60:63], v[176:179], v[80:95]
    ds_read_b64_tr_b16 v[56:57], v4 offset:4096
    ds_read_b64_tr_b16 v[58:59], v4 offset:4608
    s_waitcnt lgkmcnt(8)
    buffer_load_dwordx4 v13, s[16:19], s39 offen offset:1024 lds
    v_xor_b32 v5, 131168, v2
    v_mfma_f32_32x32x16_bf16 v[64:79], v[248:251], v[180:183], v[64:79]
    ds_read_b128 v[188:191], v5
    ds_read_b64_tr_b16 v[60:61], v3 offset:6144
    ds_read_b64_tr_b16 v[62:63], v3 offset:6656
    s_waitcnt lgkmcnt(9)
    s_waitcnt vmcnt(8)
    s_barrier
    v_mfma_f32_32x32x16_bf16 v[80:95], v[48:51], v[180:183], v[80:95]
    ds_read_b64_tr_b16 v[248:249], v4 offset:6144
    ds_read_b64_tr_b16 v[250:251], v4 offset:6656
    s_waitcnt lgkmcnt(7)
    s_add_u32 m0, s40, 98304
    s_mul_i32 s39, s33, 1792
    s_add_u32 s39, s39, 128
    buffer_load_dwordx4 v12, s[16:19], s39 offen lds
    v_or_b32 v3, 32768, v44
    v_xor_b32 v4, 32800, v44
    v_xor_b32 v5, 16384, v2
    v_mfma_f32_32x32x16_bf16 v[64:79], v[52:55], v[184:187], v[64:79]
    ds_read_b128 v[192:195], v5
    ds_read_b64_tr_b16 v[48:49], v3
    ds_read_b64_tr_b16 v[50:51], v3 offset:512
    s_waitcnt lgkmcnt(8)
    v_mfma_f32_32x32x16_bf16 v[80:95], v[56:59], v[184:187], v[80:95]
    ds_read_b64_tr_b16 v[52:53], v4
    ds_read_b64_tr_b16 v[54:55], v4 offset:512
    s_waitcnt lgkmcnt(7)
    buffer_load_dwordx4 v13, s[16:19], s39 offen offset:1024 lds
    v_xor_b32 v5, 16416, v2
    s_add_u32 s75, s59, 4096
    buffer_store_dwordx4 v[32:35], v7, s[20:23], s75 offen sc1
    v_mfma_f32_32x32x16_bf16 v[64:79], v[60:63], v[188:191], v[64:79]
    ds_read_b128 v[196:199], v5
    ds_read_b64_tr_b16 v[56:57], v3 offset:2048
    ds_read_b64_tr_b16 v[58:59], v3 offset:2560
    s_waitcnt lgkmcnt(8)
    v_mfma_f32_32x32x16_bf16 v[80:95], v[248:251], v[188:191], v[80:95]
    ds_read_b64_tr_b16 v[60:61], v4 offset:2048
    ds_read_b64_tr_b16 v[62:63], v4 offset:2560
    s_waitcnt lgkmcnt(7)
    s_add_u32 m0, s40, 114688
    s_mul_i32 s39, s34, 1792
    s_add_u32 s39, s39, 128
    buffer_load_dwordx4 v12, s[16:19], s39 offen lds
    v_xor_b32 v5, 16448, v2
    v_mfma_f32_32x32x16_bf16 v[64:79], v[48:51], v[192:195], v[64:79]
    ds_read_b128 v[200:203], v5
    ds_read_b64_tr_b16 v[248:249], v3 offset:4096
    ds_read_b64_tr_b16 v[250:251], v3 offset:4608
    s_waitcnt lgkmcnt(8)
    v_mfma_f32_32x32x16_bf16 v[80:95], v[52:55], v[192:195], v[80:95]
    ds_read_b64_tr_b16 v[48:49], v4 offset:4096
    ds_read_b64_tr_b16 v[50:51], v4 offset:4608
    s_waitcnt lgkmcnt(7)
    buffer_load_dwordx4 v13, s[16:19], s39 offen offset:1024 lds
    v_xor_b32 v5, 16480, v2
    v_mfma_f32_32x32x16_bf16 v[64:79], v[56:59], v[196:199], v[64:79]
    ds_read_b128 v[204:207], v5
    ds_read_b64_tr_b16 v[52:53], v3 offset:6144
    ds_read_b64_tr_b16 v[54:55], v3 offset:6656
    s_waitcnt lgkmcnt(8)
    s_waitcnt vmcnt(8)
    s_barrier
    v_mfma_f32_32x32x16_bf16 v[80:95], v[60:63], v[196:199], v[80:95]
    ds_read_b64_tr_b16 v[56:57], v4 offset:6144
    ds_read_b64_tr_b16 v[58:59], v4 offset:6656
    s_waitcnt lgkmcnt(7)
    s_add_u32 m0, s40, 131072
    s_mul_i32 s39, s35, 1792
    s_add_u32 s39, s39, 128
    buffer_load_dwordx4 v12, s[16:19], s39 offen lds
    v_or_b32 v3, 65536, v44
    v_xor_b32 v4, 65568, v44
    v_xor_b32 v5, 49152, v2
    v_mfma_f32_32x32x16_bf16 v[64:79], v[248:251], v[200:203], v[64:79]
    ds_read_b128 v[208:211], v5
    ds_read_b64_tr_b16 v[60:61], v3
    ds_read_b64_tr_b16 v[62:63], v3 offset:512
    s_waitcnt lgkmcnt(8)
    v_mfma_f32_32x32x16_bf16 v[80:95], v[48:51], v[200:203], v[80:95]
    ds_read_b64_tr_b16 v[248:249], v4
    ds_read_b64_tr_b16 v[250:251], v4 offset:512
    s_waitcnt lgkmcnt(7)
    buffer_load_dwordx4 v13, s[16:19], s39 offen offset:1024 lds
    v_xor_b32 v5, 49184, v2
    buffer_store_dwordx4 v[32:35], v7, s[20:23], s75 offen offset:1024 sc1
    v_mfma_f32_32x32x16_bf16 v[64:79], v[52:55], v[204:207], v[64:79]
    ds_read_b128 v[212:215], v5
    ds_read_b64_tr_b16 v[48:49], v3 offset:2048
    ds_read_b64_tr_b16 v[50:51], v3 offset:2560
    s_waitcnt lgkmcnt(8)
    v_mfma_f32_32x32x16_bf16 v[80:95], v[56:59], v[204:207], v[80:95]
    ds_read_b64_tr_b16 v[52:53], v4 offset:2048
    ds_read_b64_tr_b16 v[54:55], v4 offset:2560
    s_waitcnt lgkmcnt(7)
    s_add_u32 m0, s40, 0
    s_mul_i32 s39, s36, 1792
    s_add_u32 s39, s39, 128
    buffer_load_dwordx4 v12, s[16:19], s39 offen lds
    v_xor_b32 v5, 49216, v2
    v_mfma_f32_32x32x16_bf16 v[64:79], v[60:63], v[208:211], v[64:79]
    ds_read_b128 v[216:219], v5
    ds_read_b64_tr_b16 v[56:57], v3 offset:4096
    ds_read_b64_tr_b16 v[58:59], v3 offset:4608
    s_waitcnt lgkmcnt(8)
    v_mfma_f32_32x32x16_bf16 v[80:95], v[248:251], v[208:211], v[80:95]
    ds_read_b64_tr_b16 v[60:61], v4 offset:4096
    ds_read_b64_tr_b16 v[62:63], v4 offset:4608
    s_waitcnt lgkmcnt(7)
    buffer_load_dwordx4 v13, s[16:19], s39 offen offset:1024 lds
    v_xor_b32 v5, 49248, v2
    v_mfma_f32_32x32x16_bf16 v[64:79], v[48:51], v[212:215], v[64:79]
    ds_read_b128 v[220:223], v5
    ds_read_b64_tr_b16 v[248:249], v3 offset:6144
    ds_read_b64_tr_b16 v[250:251], v3 offset:6656
    s_waitcnt lgkmcnt(8)
    v_lshrrev_b32 v16, 3, v1
    v_mul_u32_u24 v16, 896, v16
    v_bfe_u32 v17, v1, 4, 1
    s_waitcnt vmcnt(10)
    s_barrier
    v_mfma_f32_32x32x16_bf16 v[80:95], v[52:55], v[212:215], v[80:95]
    ds_read_b64_tr_b16 v[48:49], v4 offset:6144
    ds_read_b64_tr_b16 v[50:51], v4 offset:6656
    s_waitcnt lgkmcnt(7)
    s_add_u32 m0, s40, 16384
    s_mul_i32 s39, s37, 1792
    s_add_u32 s39, s39, 128
    buffer_load_dwordx4 v12, s[16:19], s39 offen lds
    v_lshlrev_b32 v17, 2, v17
    v_or_b32 v3, 81920, v44
    v_xor_b32 v4, 81952, v44
    v_mfma_f32_32x32x16_bf16 v[64:79], v[56:59], v[216:219], v[64:79]
    ds_read_b64_tr_b16 v[52:53], v3
    ds_read_b64_tr_b16 v[54:55], v3 offset:512
    s_waitcnt lgkmcnt(7)
    v_and_b32 v18, 7, v1
    v_xor_b32 v17, v17, v18
    v_lshl_add_u32 v16, v17, 4, v16
    s_lshl_b32 s71, s62, 7
    s_lshl_b32 s72, s63, 30
    s_lshl_b32 s72, s72, 0
    s_add_u32 s71, s71, s72
    s_and_b32 s72, s3, 3
    s_mul_i32 s72, s72, 14336
    s_add_u32 s72, s72, s71
    v_mfma_f32_32x32x16_bf16 v[80:95], v[60:63], v[216:219], v[80:95]
    ds_read_b64_tr_b16 v[56:57], v4
    ds_read_b64_tr_b16 v[58:59], v4 offset:512
    s_waitcnt lgkmcnt(6)
    buffer_load_dwordx4 v13, s[16:19], s39 offen offset:1024 lds
    v_add_u32 v8, s72, v16
    v_add_u32 v9, 6144, v8
    s_mul_i32 s72, s70, 25088
    s_add_u32 s71, s71, s72
    s_and_b32 s72, s3, 1
    s_mul_i32 s72, s72, 14336
    s_add_u32 s71, s71, s72
    v_add_u32 v10, s71, v16
    v_and_b32 v36, 7, v1
    v_lshlrev_b32 v36, 4, v36
    s_mov_b64 exec, 0xff
    buffer_store_dwordx2 v[32:33], v36, s[20:23], s67 offen sc1
    s_mov_b64 exec, -1
    v_mfma_f32_32x32x16_bf16 v[64:79], v[248:251], v[220:223], v[64:79]
    ds_read_b64_tr_b16 v[60:61], v3 offset:2048
    ds_read_b64_tr_b16 v[62:63], v3 offset:2560
    s_waitcnt lgkmcnt(6)
    v_add_u32 v11, 6144, v10
    v_mfma_f32_32x32x16_bf16 v[80:95], v[48:51], v[220:223], v[80:95]
    ds_read_b64_tr_b16 v[248:249], v4 offset:2048
    ds_read_b64_tr_b16 v[250:251], v4 offset:2560
    s_waitcnt lgkmcnt(6)
    s_add_u32 m0, s40, 32768
    s_mul_i32 s39, s38, 1792
    s_add_u32 s39, s39, 128
    buffer_load_dwordx4 v12, s[16:19], s39 offen lds
    v_mfma_f32_32x32x16_bf16 v[96:111], v[52:55], v[128:131], 0
    ds_read_b64_tr_b16 v[48:49], v3 offset:4096
    ds_read_b64_tr_b16 v[50:51], v3 offset:4608
    s_waitcnt lgkmcnt(6)
    v_mfma_f32_32x32x16_bf16 v[112:127], v[56:59], v[128:131], 0
    ds_read_b64_tr_b16 v[52:53], v4 offset:4096
    ds_read_b64_tr_b16 v[54:55], v4 offset:4608
    s_waitcnt lgkmcnt(6)
    buffer_load_dwordx4 v13, s[16:19], s39 offen offset:1024 lds
    v_mul_f32 v16, v64, v64
    v_mul_f32 v17, v65, v65
    v_mul_f32 v18, v66, v66
    v_mul_f32 v19, v67, v67
    v_mul_f32 v20, v68, v68
    v_mul_f32 v21, v69, v69
    v_mfma_f32_32x32x16_bf16 v[96:111], v[60:63], v[132:135], v[96:111]
    ds_read_b64_tr_b16 v[56:57], v3 offset:6144
    ds_read_b64_tr_b16 v[58:59], v3 offset:6656
    s_waitcnt lgkmcnt(6)
    v_mul_f32 v22, v70, v70
    v_mul_f32 v23, v71, v71
    v_fma_f32 v16, v16, s49, v47
    v_mul_f32 v72, v64, v72
    v_fma_f32 v17, v17, s49, v47
    v_mul_f32 v73, v65, v73
    s_waitcnt vmcnt(13)
    s_barrier
    s_cmp_lg_u32 s3, 0
    s_cbranch_scc1 L_w081
    buffer_load_dword v253, off, s[24:27], 0 sc1
L_w081:
    v_mfma_f32_32x32x16_bf16 v[112:127], v[248:251], v[132:135], v[112:127]
    ds_read_b64_tr_b16 v[60:61], v4 offset:6144
    ds_read_b64_tr_b16 v[62:63], v4 offset:6656
    s_waitcnt lgkmcnt(6)
    s_add_u32 m0, s41, 49152
    s_mul_i32 s39, s32, 1344
    buffer_load_dwordx4 v43, s[12:15], s39 offen lds
    v_fma_f32 v18, v18, s49, v47
    v_mul_f32 v74, v66, v74
    v_fma_f32 v19, v19, s49, v47
    v_mul_f32 v75, v67, v75
    v_or_b32 v3, 98304, v44
    v_xor_b32 v4, 98336, v44
    v_mfma_f32_32x32x16_bf16 v[96:111], v[48:51], v[136:139], v[96:111]
    ds_read_b64_tr_b16 v[248:249], v3
    ds_read_b64_tr_b16 v[250:251], v3 offset:512
    s_waitcnt lgkmcnt(6)
    v_fma_f32 v20, v20, s49, v47
    v_mul_f32 v76, v68, v76
    v_fma_f32 v21, v21, s49, v47
    v_mul_f32 v77, v69, v77
    v_fma_f32 v22, v22, s49, v47
    v_mul_f32 v78, v70, v78
    v_mfma_f32_32x32x16_bf16 v[112:127], v[52:55], v[136:139], v[112:127]
    ds_read_b64_tr_b16 v[48:49], v4
    ds_read_b64_tr_b16 v[50:51], v4 offset:512
    s_waitcnt lgkmcnt(6)
    s_add_u32 m0, s41, 57344
    s_mul_i32 s39, s33, 1344
    buffer_load_dwordx4 v43, s[12:15], s39 offen lds
    v_fma_f32 v23, v23, s49, v47
    v_mul_f32 v79, v71, v79
    v_mul_f32 v16, v16, v64
    v_mul_f32 v17, v17, v65
    v_mul_f32 v18, v18, v66
    v_mul_f32 v19, v19, v67
    v_and_b32 v36, 31, v1
    v_lshlrev_b32 v36, 2, v36
    s_or_b32 s43, s5, s58
    s_cmp_lg_u32 s43, 0
    s_cbranch_scc1 L_gi80
    buffer_store_dword v32, v36, s[20:23], s76 offen sc1
L_gi80:
    v_mfma_f32_32x32x16_bf16 v[96:111], v[56:59], v[140:143], v[96:111]
    ds_read_b64_tr_b16 v[52:53], v3 offset:2048
    ds_read_b64_tr_b16 v[54:55], v3 offset:2560
    s_waitcnt lgkmcnt(6)
    v_mul_f32 v20, v20, v68
    v_mul_f32 v21, v21, v69
    v_mul_f32 v22, v22, v70
    v_mul_f32 v23, v23, v71
    v_exp_f32 v16, v16
    v_mfma_f32_32x32x16_bf16 v[112:127], v[60:63], v[140:143], v[112:127]
    ds_read_b64_tr_b16 v[56:57], v4 offset:2048
    ds_read_b64_tr_b16 v[58:59], v4 offset:2560
    s_waitcnt lgkmcnt(6)
    s_add_u32 m0, s41, 65536
    s_mul_i32 s39, s34, 1344
    buffer_load_dwordx4 v43, s[12:15], s39 offen lds
    v_exp_f32 v17, v17
    v_exp_f32 v18, v18
    v_add_f32 v16, 1.0, v16
    v_mfma_f32_32x32x16_bf16 v[96:111], v[248:251], v[144:147], v[96:111]
    ds_read_b64_tr_b16 v[60:61], v3 offset:4096
    ds_read_b64_tr_b16 v[62:63], v3 offset:4608
    s_waitcnt lgkmcnt(6)
    v_exp_f32 v19, v19
    v_add_f32 v17, 1.0, v17
    v_exp_f32 v20, v20
    v_add_f32 v18, 1.0, v18
    v_mfma_f32_32x32x16_bf16 v[112:127], v[48:51], v[144:147], v[112:127]
    ds_read_b64_tr_b16 v[248:249], v4 offset:4096
    ds_read_b64_tr_b16 v[250:251], v4 offset:4608
    s_waitcnt lgkmcnt(6)
    s_add_u32 m0, s41, 73728
    s_mul_i32 s39, s35, 1344
    buffer_load_dwordx4 v43, s[12:15], s39 offen lds
    v_exp_f32 v21, v21
    v_add_f32 v19, 1.0, v19
    v_exp_f32 v22, v22
    v_add_f32 v20, 1.0, v20
    v_mfma_f32_32x32x16_bf16 v[96:111], v[52:55], v[148:151], v[96:111]
    ds_read_b64_tr_b16 v[48:49], v3 offset:6144
    ds_read_b64_tr_b16 v[50:51], v3 offset:6656
    s_waitcnt lgkmcnt(6)
    v_exp_f32 v23, v23
    v_add_f32 v21, 1.0, v21
    v_add_f32 v22, 1.0, v22
    v_add_f32 v23, 1.0, v23
    s_waitcnt vmcnt(14)
    s_barrier
    v_mfma_f32_32x32x16_bf16 v[112:127], v[56:59], v[148:151], v[112:127]
    ds_read_b64_tr_b16 v[52:53], v4 offset:6144
    ds_read_b64_tr_b16 v[54:55], v4 offset:6656
    s_waitcnt lgkmcnt(6)
    s_add_u32 m0, s41, 81920
    s_mul_i32 s39, s36, 1344
    buffer_load_dwordx4 v43, s[12:15], s39 offen lds
    v_rcp_f32 v16, v16
    v_rcp_f32 v17, v17
    v_or_b32 v3, 114688, v44
    v_xor_b32 v4, 114720, v44
    v_mfma_f32_32x32x16_bf16 v[96:111], v[60:63], v[152:155], v[96:111]
    ds_read_b64_tr_b16 v[56:57], v3
    ds_read_b64_tr_b16 v[58:59], v3 offset:512
    s_waitcnt lgkmcnt(6)
    v_rcp_f32 v18, v18
    v_mul_f32 v72, v72, v16
    v_rcp_f32 v19, v19
    v_mul_f32 v73, v73, v17
    v_mfma_f32_32x32x16_bf16 v[112:127], v[248:251], v[152:155], v[112:127]
    ds_read_b64_tr_b16 v[60:61], v4
    ds_read_b64_tr_b16 v[62:63], v4 offset:512
    s_waitcnt lgkmcnt(6)
    s_add_u32 m0, s41, 90112
    s_mul_i32 s39, s37, 1344
    buffer_load_dwordx4 v43, s[12:15], s39 offen lds
    v_rcp_f32 v20, v20
    v_mul_f32 v74, v74, v18
    v_rcp_f32 v21, v21
    v_mul_f32 v75, v75, v19
    v_mfma_f32_32x32x16_bf16 v[96:111], v[48:51], v[156:159], v[96:111]
    ds_read_b64_tr_b16 v[248:249], v3 offset:2048
    ds_read_b64_tr_b16 v[250:251], v3 offset:2560
    s_waitcnt lgkmcnt(6)
    v_rcp_f32 v22, v22
    v_mul_f32 v76, v76, v20
    v_rcp_f32 v23, v23
    v_mul_f32 v77, v77, v21
    v_mfma_f32_32x32x16_bf16 v[112:127], v[52:55], v[156:159], v[112:127]
    ds_read_b64_tr_b16 v[48:49], v4 offset:2048
    ds_read_b64_tr_b16 v[50:51], v4 offset:2560
    s_waitcnt lgkmcnt(6)
    v_mul_f32 v78, v78, v22
    v_mul_f32 v79, v79, v23
    v_cvt_pk_bf16_f32 v24, v72, v73
    v_cvt_pk_bf16_f32 v25, v74, v75
    v_cvt_pk_bf16_f32 v26, v76, v77
    v_cvt_pk_bf16_f32 v27, v78, v79
    v_mfma_f32_32x32x16_bf16 v[96:111], v[56:59], v[160:163], v[96:111]
    ds_read_b64_tr_b16 v[52:53], v3 offset:4096
    ds_read_b64_tr_b16 v[54:55], v3 offset:4608
    s_waitcnt lgkmcnt(6)
    buffer_store_dwordx4 v[24:27], v7, s[20:23], s59 offen sc1
    v_mul_f32 v16, v80, v80
    v_mul_f32 v17, v81, v81
    v_mul_f32 v18, v82, v82
    v_mul_f32 v19, v83, v83
    v_mul_f32 v20, v84, v84
    v_mfma_f32_32x32x16_bf16 v[112:127], v[60:63], v[160:163], v[112:127]
    ds_read_b64_tr_b16 v[56:57], v4 offset:4096
    ds_read_b64_tr_b16 v[58:59], v4 offset:4608
    s_waitcnt lgkmcnt(6)
    v_mul_f32 v21, v85, v85
    v_mul_f32 v22, v86, v86
    v_mul_f32 v23, v87, v87
    v_fma_f32 v16, v16, s49, v47
    v_mul_f32 v88, v80, v88
    v_fma_f32 v17, v17, s49, v47
    v_mfma_f32_32x32x16_bf16 v[96:111], v[248:251], v[164:167], v[96:111]
    ds_read_b64_tr_b16 v[60:61], v3 offset:6144
    ds_read_b64_tr_b16 v[62:63], v3 offset:6656
    s_waitcnt lgkmcnt(6)
    v_mul_f32 v89, v81, v89
    v_fma_f32 v18, v18, s49, v47
    v_mul_f32 v90, v82, v90
    v_fma_f32 v19, v19, s49, v47
    v_mul_f32 v91, v83, v91
    v_fma_f32 v20, v20, s49, v47
    s_waitcnt vmcnt(15)
    s_barrier
    v_mfma_f32_32x32x16_bf16 v[112:127], v[48:51], v[164:167], v[112:127]
    ds_read_b64_tr_b16 v[248:249], v4 offset:6144
    ds_read_b64_tr_b16 v[250:251], v4 offset:6656
    s_waitcnt lgkmcnt(6)
    s_add_u32 m0, s41, 98304
    s_mul_i32 s39, s38, 1344
    buffer_load_dwordx4 v43, s[12:15], s39 offen lds
    v_mul_f32 v92, v84, v92
    v_fma_f32 v21, v21, s49, v47
    v_mul_f32 v93, v85, v93
    v_fma_f32 v22, v22, s49, v47
    v_or_b32 v3, 131072, v44
    v_xor_b32 v4, 131104, v44
    v_mfma_f32_32x32x16_bf16 v[96:111], v[52:55], v[168:171], v[96:111]
    ds_read_b64_tr_b16 v[48:49], v3
    ds_read_b64_tr_b16 v[50:51], v3 offset:512
    s_waitcnt lgkmcnt(6)
    v_mul_f32 v94, v86, v94
    v_fma_f32 v23, v23, s49, v47
    v_mul_f32 v95, v87, v95
    v_mul_f32 v16, v16, v80
    v_mul_f32 v17, v17, v81
    v_mul_f32 v18, v18, v82
    v_mfma_f32_32x32x16_bf16 v[112:127], v[56:59], v[168:171], v[112:127]
    ds_read_b64_tr_b16 v[52:53], v4
    ds_read_b64_tr_b16 v[54:55], v4 offset:512
    s_waitcnt lgkmcnt(6)
    s_cmp_gt_u32 s3, 1
    s_cbranch_scc1 L_tw107
    s_cmp_eq_u32 s3, 1
    s_cbranch_scc1 L_tw106
    s_mul_i32 s43, s2, 6272
    v_min_u32 v0, 48, v1
    v_lshlrev_b32 v0, 7, v0
    buffer_load_dword v0, v0, s[88:91], s43 offen
    s_branch L_tw107
L_tw106:
    s_mul_i32 s43, s2, 1664
    s_waitcnt vmcnt(0)
    v_min_u32 v0, 12, v1
    s_waitcnt vmcnt(0)
    v_lshlrev_b32 v0, 7, v0
    s_waitcnt vmcnt(0)
    buffer_load_dword v0, v0, s[92:95], s43 offen
L_tw107:
    v_mul_f32 v19, v19, v83
    v_mul_f32 v20, v20, v84
    v_mul_f32 v21, v21, v85
    v_mul_f32 v22, v22, v86
    v_mul_f32 v23, v23, v87
    v_mfma_f32_32x32x16_bf16 v[96:111], v[60:63], v[172:175], v[96:111]
    ds_read_b64_tr_b16 v[56:57], v3 offset:2048
    ds_read_b64_tr_b16 v[58:59], v3 offset:2560
    s_waitcnt lgkmcnt(6)
    v_exp_f32 v16, v16
    v_exp_f32 v17, v17
    v_exp_f32 v18, v18
    v_mfma_f32_32x32x16_bf16 v[112:127], v[248:251], v[172:175], v[112:127]
    ds_read_b64_tr_b16 v[60:61], v4 offset:2048
    ds_read_b64_tr_b16 v[62:63], v4 offset:2560
    s_waitcnt lgkmcnt(6)
    v_add_f32 v16, 1.0, v16
    v_exp_f32 v19, v19
    v_add_f32 v17, 1.0, v17
    v_exp_f32 v20, v20
    v_mfma_f32_32x32x16_bf16 v[96:111], v[48:51], v[176:179], v[96:111]
    ds_read_b64_tr_b16 v[248:249], v3 offset:4096
    ds_read_b64_tr_b16 v[250:251], v3 offset:4608
    s_waitcnt lgkmcnt(6)
    v_add_f32 v18, 1.0, v18
    v_exp_f32 v21, v21
    v_add_f32 v19, 1.0, v19
    v_exp_f32 v22, v22
    v_mfma_f32_32x32x16_bf16 v[112:127], v[52:55], v[176:179], v[112:127]
    ds_read_b64_tr_b16 v[48:49], v4 offset:4096
    ds_read_b64_tr_b16 v[50:51], v4 offset:4608
    s_waitcnt lgkmcnt(6)
    v_add_f32 v20, 1.0, v20
    v_exp_f32 v23, v23
    v_add_f32 v21, 1.0, v21
    v_add_f32 v22, 1.0, v22
    v_add_f32 v23, 1.0, v23
    v_mfma_f32_32x32x16_bf16 v[96:111], v[56:59], v[180:183], v[96:111]
    ds_read_b64_tr_b16 v[52:53], v3 offset:6144
    ds_read_b64_tr_b16 v[54:55], v3 offset:6656
    s_waitcnt lgkmcnt(6)
    v_rcp_f32 v16, v16
    v_rcp_f32 v17, v17
    v_rcp_f32 v18, v18
    s_cmp_lg_u32 s3, 0
    s_cbranch_scc1 L_w084
    s_waitcnt vmcnt(8)
    s_mov_b32 s73, 0
L_sp82:
    v_readfirstlane_b32 s43, v253
    s_nop 1
    s_and_b32 s43, s43, 0x1
    s_cmp_eq_u32 s43, 0x1
    s_cbranch_scc1 L_ok83
    s_add_u32 s73, s73, 1
    s_cmp_gt_u32 s73, 100000
    s_cbranch_scc1 L_ok83
    s_sleep 2
    buffer_load_dword v253, off, s[24:27], 0 sc1
    s_waitcnt vmcnt(0)
    s_branch L_sp82
L_ok83:
L_w084:
    s_waitcnt vmcnt(13)
    s_barrier
    v_mfma_f32_32x32x16_bf16 v[112:127], v[60:63], v[180:183], v[112:127]
    ds_read_b64_tr_b16 v[56:57], v4 offset:6144
    ds_read_b64_tr_b16 v[58:59], v4 offset:6656
    s_waitcnt lgkmcnt(6)
    s_mul_i32 s39, s58, 286720
    s_mul_i32 m0, s84, 401408
    s_add_u32 s39, s39, m0
    s_add_u32 m0, s40, 114688
    s_nop 0
    buffer_load_dwordx4 v8, s[88:91], s39 offen lds
    v_mul_f32 v88, v88, v16
    v_rcp_f32 v19, v19
    v_mul_f32 v89, v89, v17
    v_or_b32 v3, 0, v44
    v_xor_b32 v4, 32, v44
    v_mfma_f32_32x32x16_bf16 v[96:111], v[248:251], v[184:187], v[96:111]
    ds_read_b64_tr_b16 v[60:61], v3
    ds_read_b64_tr_b16 v[62:63], v3 offset:512
    s_waitcnt lgkmcnt(6)
    v_rcp_f32 v20, v20
    v_mul_f32 v90, v90, v18
    v_rcp_f32 v21, v21
    v_mul_f32 v91, v91, v19
    v_mfma_f32_32x32x16_bf16 v[112:127], v[48:51], v[184:187], v[112:127]
    ds_read_b64_tr_b16 v[248:249], v4
    ds_read_b64_tr_b16 v[250:251], v4 offset:512
    s_waitcnt lgkmcnt(6)
    buffer_load_dwordx4 v9, s[88:91], s39 offen offset:1024 lds
    v_rcp_f32 v22, v22
    v_mul_f32 v92, v92, v20
    v_rcp_f32 v23, v23
    v_mul_f32 v93, v93, v21
    v_mfma_f32_32x32x16_bf16 v[96:111], v[52:55], v[188:191], v[96:111]
    ds_read_b64_tr_b16 v[48:49], v3 offset:2048
    ds_read_b64_tr_b16 v[50:51], v3 offset:2560
    s_waitcnt lgkmcnt(6)
    v_mul_f32 v94, v94, v22
    v_mul_f32 v95, v95, v23
    v_cvt_pk_bf16_f32 v80, v88, v89
    v_cvt_pk_bf16_f32 v81, v90, v91
    v_cvt_pk_bf16_f32 v82, v92, v93
    v_cvt_pk_bf16_f32 v83, v94, v95
    v_mfma_f32_32x32x16_bf16 v[112:127], v[56:59], v[188:191], v[112:127]
    ds_read_b64_tr_b16 v[52:53], v4 offset:2048
    ds_read_b64_tr_b16 v[54:55], v4 offset:2560
    s_waitcnt lgkmcnt(6)
    buffer_store_dwordx4 v[80:83], v7, s[20:23], s59 offen offset:1024 sc1
    v_mfma_f32_32x32x16_bf16 v[96:111], v[60:63], v[192:195], v[96:111]
    ds_read_b64_tr_b16 v[56:57], v3 offset:4096
    ds_read_b64_tr_b16 v[58:59], v3 offset:4608
    s_waitcnt lgkmcnt(6)
    v_mfma_f32_32x32x16_bf16 v[112:127], v[248:251], v[192:195], v[112:127]
    ds_read_b64_tr_b16 v[60:61], v4 offset:4096
    ds_read_b64_tr_b16 v[62:63], v4 offset:4608
    s_waitcnt lgkmcnt(6)
    v_mfma_f32_32x32x16_bf16 v[96:111], v[48:51], v[196:199], v[96:111]
    ds_read_b64_tr_b16 v[248:249], v3 offset:6144
    ds_read_b64_tr_b16 v[250:251], v3 offset:6656
    s_waitcnt lgkmcnt(6)
    s_waitcnt vmcnt(14)
    s_barrier
    v_mfma_f32_32x32x16_bf16 v[112:127], v[52:55], v[196:199], v[112:127]
    ds_read_b64_tr_b16 v[48:49], v4 offset:6144
    ds_read_b64_tr_b16 v[50:51], v4 offset:6656
    s_waitcnt lgkmcnt(6)
    s_mul_i32 s39, s58, 286720
    s_mul_i32 m0, s85, 401408
    s_add_u32 s39, s39, m0
    s_add_u32 m0, s40, 131072
    s_nop 0
    buffer_load_dwordx4 v8, s[88:91], s39 offen lds
    v_or_b32 v3, 16384, v44
    v_xor_b32 v4, 16416, v44
    v_mfma_f32_32x32x16_bf16 v[96:111], v[56:59], v[200:203], v[96:111]
    ds_read_b64_tr_b16 v[52:53], v3
    ds_read_b64_tr_b16 v[54:55], v3 offset:512
    s_waitcnt lgkmcnt(6)
    v_mfma_f32_32x32x16_bf16 v[112:127], v[60:63], v[200:203], v[112:127]
    ds_read_b64_tr_b16 v[56:57], v4
    ds_read_b64_tr_b16 v[58:59], v4 offset:512
    s_waitcnt lgkmcnt(6)
    buffer_load_dwordx4 v9, s[88:91], s39 offen offset:1024 lds
    v_mfma_f32_32x32x16_bf16 v[96:111], v[248:251], v[204:207], v[96:111]
    ds_read_b64_tr_b16 v[60:61], v3 offset:2048
    ds_read_b64_tr_b16 v[62:63], v3 offset:2560
    s_waitcnt lgkmcnt(6)
    v_mfma_f32_32x32x16_bf16 v[112:127], v[48:51], v[204:207], v[112:127]
    ds_read_b64_tr_b16 v[248:249], v4 offset:2048
    ds_read_b64_tr_b16 v[250:251], v4 offset:2560
    s_waitcnt lgkmcnt(6)
    v_mfma_f32_32x32x16_bf16 v[96:111], v[52:55], v[208:211], v[96:111]
    ds_read_b64_tr_b16 v[48:49], v3 offset:4096
    ds_read_b64_tr_b16 v[50:51], v3 offset:4608
    s_waitcnt lgkmcnt(6)
    v_mfma_f32_32x32x16_bf16 v[112:127], v[56:59], v[208:211], v[112:127]
    ds_read_b64_tr_b16 v[52:53], v4 offset:4096
    ds_read_b64_tr_b16 v[54:55], v4 offset:4608
    s_waitcnt lgkmcnt(6)
    v_mfma_f32_32x32x16_bf16 v[96:111], v[60:63], v[212:215], v[96:111]
    ds_read_b64_tr_b16 v[56:57], v3 offset:6144
    ds_read_b64_tr_b16 v[58:59], v3 offset:6656
    s_waitcnt lgkmcnt(6)
    s_waitcnt vmcnt(13)
    s_barrier
    v_mfma_f32_32x32x16_bf16 v[112:127], v[248:251], v[212:215], v[112:127]
    ds_read_b64_tr_b16 v[60:61], v4 offset:6144
    ds_read_b64_tr_b16 v[62:63], v4 offset:6656
    s_waitcnt lgkmcnt(6)
    s_mul_i32 s39, s58, 286720
    s_mul_i32 m0, s86, 401408
    s_add_u32 s39, s39, m0
    s_add_u32 m0, s40, 0
    s_nop 0
    buffer_load_dwordx4 v8, s[88:91], s39 offen lds
    v_or_b32 v3, 32768, v44
    v_xor_b32 v4, 32800, v44
    v_mfma_f32_32x32x16_bf16 v[96:111], v[48:51], v[216:219], v[96:111]
    ds_read_b64_tr_b16 v[248:249], v3
    ds_read_b64_tr_b16 v[250:251], v3 offset:512
    s_waitcnt lgkmcnt(6)
    v_mfma_f32_32x32x16_bf16 v[112:127], v[52:55], v[216:219], v[112:127]
    ds_read_b64_tr_b16 v[48:49], v4
    ds_read_b64_tr_b16 v[50:51], v4 offset:512
    s_waitcnt lgkmcnt(6)
    buffer_load_dwordx4 v9, s[88:91], s39 offen offset:1024 lds
    v_mfma_f32_32x32x16_bf16 v[96:111], v[56:59], v[220:223], v[96:111]
    ds_read_b64_tr_b16 v[52:53], v3 offset:2048
    ds_read_b64_tr_b16 v[54:55], v3 offset:2560
    s_waitcnt lgkmcnt(6)
    v_mfma_f32_32x32x16_bf16 v[112:127], v[60:63], v[220:223], v[112:127]
    ds_read_b64_tr_b16 v[56:57], v4 offset:2048
    ds_read_b64_tr_b16 v[58:59], v4 offset:2560
    s_waitcnt lgkmcnt(6)
    v_mfma_f32_32x32x16_bf16 v[96:111], v[248:251], v[224:227], v[96:111]
    ds_read_b64_tr_b16 v[60:61], v3 offset:4096
    ds_read_b64_tr_b16 v[62:63], v3 offset:4608
    s_waitcnt lgkmcnt(6)
    v_mfma_f32_32x32x16_bf16 v[112:127], v[48:51], v[224:227], v[112:127]
    ds_read_b64_tr_b16 v[248:249], v4 offset:4096
    ds_read_b64_tr_b16 v[250:251], v4 offset:4608
    s_waitcnt lgkmcnt(6)
    v_mfma_f32_32x32x16_bf16 v[96:111], v[52:55], v[228:231], v[96:111]
    ds_read_b64_tr_b16 v[48:49], v3 offset:6144
    ds_read_b64_tr_b16 v[50:51], v3 offset:6656
    s_waitcnt lgkmcnt(6)
    s_waitcnt vmcnt(4)
    s_barrier
    s_cmp_lg_u32 s3, 0
    s_cbranch_scc1 L_w093
    s_mov_b64 exec, 1
    v_mov_b32 v255, 1
    buffer_atomic_add v255, off, s[20:23], s80 sc1
    v_mov_b32 v254, 256
    buffer_atomic_add v254, off, s[20:23], s82 sc1
    s_mov_b64 exec, -1
L_w093:
    v_mfma_f32_32x32x16_bf16 v[112:127], v[56:59], v[228:231], v[112:127]
    ds_read_b64_tr_b16 v[52:53], v4 offset:6144
    ds_read_b64_tr_b16 v[54:55], v4 offset:6656
    s_waitcnt lgkmcnt(6)
    s_mul_i32 s39, s58, 286720
    s_mul_i32 m0, s87, 401408
    s_add_u32 s39, s39, m0
    s_add_u32 m0, s40, 16384
    s_nop 0
    buffer_load_dwordx4 v8, s[88:91], s39 offen lds
    v_and_b32 v3, 49152, v45
    v_or_b32 v3, v3, v46
    v_mfma_f32_32x32x16_bf16 v[96:111], v[60:63], v[232:235], v[96:111]
    ds_read_b64_tr_b16 v[56:57], v3
    ds_read_b64_tr_b16 v[58:59], v3 offset:512
    s_waitcnt lgkmcnt(6)
    v_mfma_f32_32x32x16_bf16 v[112:127], v[248:251], v[232:235], v[112:127]
    ds_read_b64_tr_b16 v[60:61], v3 offset:2048
    ds_read_b64_tr_b16 v[62:63], v3 offset:2560
    s_waitcnt lgkmcnt(6)
    buffer_load_dwordx4 v9, s[88:91], s39 offen offset:1024 lds
    v_mfma_f32_32x32x16_bf16 v[96:111], v[48:51], v[236:239], v[96:111]
    ds_read_b64_tr_b16 v[248:249], v3 offset:4096
    ds_read_b64_tr_b16 v[250:251], v3 offset:4608
    s_waitcnt lgkmcnt(6)
    v_mfma_f32_32x32x16_bf16 v[112:127], v[52:55], v[236:239], v[112:127]
    ds_read_b64_tr_b16 v[48:49], v3 offset:6144
    ds_read_b64_tr_b16 v[50:51], v3 offset:6656
    s_waitcnt lgkmcnt(6)
    v_mfma_f32_32x32x16_bf16 v[64:79], v[56:59], v[128:131], 0
    ds_read_b64_tr_b16 v[52:53], v3 offset:8192
    ds_read_b64_tr_b16 v[54:55], v3 offset:8704
    s_waitcnt lgkmcnt(6)
    v_mfma_f32_32x32x16_bf16 v[64:79], v[60:63], v[132:135], v[64:79]
    ds_read_b64_tr_b16 v[56:57], v3 offset:10240
    ds_read_b64_tr_b16 v[58:59], v3 offset:10752
    s_waitcnt lgkmcnt(6)
    s_add_u32 s59, s59, 4096
    v_mul_f32 v16, v96, v96
    v_mul_f32 v17, v97, v97
    v_mul_f32 v18, v98, v98
    v_mul_f32 v19, v99, v99
    v_mul_f32 v20, v100, v100
    v_mul_f32 v21, v101, v101
    v_mfma_f32_32x32x16_bf16 v[64:79], v[248:251], v[136:139], v[64:79]
    ds_read_b64_tr_b16 v[60:61], v3 offset:12288
    ds_read_b64_tr_b16 v[62:63], v3 offset:12800
    s_waitcnt lgkmcnt(6)
    v_mul_f32 v22, v102, v102
    v_mul_f32 v23, v103, v103
    v_fma_f32 v16, v16, s49, v47
    v_mul_f32 v104, v96, v104
    v_fma_f32 v17, v17, s49, v47
    v_mul_f32 v105, v97, v105
    s_barrier
    v_mfma_f32_32x32x16_bf16 v[64:79], v[48:51], v[140:143], v[64:79]
    ds_read_b64_tr_b16 v[248:249], v3 offset:14336
    ds_read_b64_tr_b16 v[250:251], v3 offset:14848
    s_waitcnt lgkmcnt(6)
    s_mul_i32 s39, s58, 286720
    s_mul_i32 m0, s84, 401408
    s_add_u32 s39, s39, m0
    s_add_u32 s39, s39, 57344
    s_add_u32 m0, s40, 32768
    s_nop 0
    buffer_load_dwordx4 v8, s[88:91], s39 offen lds
    v_fma_f32 v18, v18, s49, v47
    v_mul_f32 v106, v98, v106
    v_fma_f32 v19, v19, s49, v47
    v_mul_f32 v107, v99, v107
    v_and_b32 v3, 65600, v45
    v_or_b32 v3, v3, v46
    v_mfma_f32_32x32x16_bf16 v[64:79], v[52:55], v[144:147], v[64:79]
    ds_read_b64_tr_b16 v[48:49], v3
    ds_read_b64_tr_b16 v[50:51], v3 offset:512
    s_waitcnt lgkmcnt(6)
    v_fma_f32 v20, v20, s49, v47
    v_mul_f32 v108, v100, v108
    v_fma_f32 v21, v21, s49, v47
    v_mul_f32 v109, v101, v109
    v_fma_f32 v22, v22, s49, v47
    v_mul_f32 v110, v102, v110
    v_mfma_f32_32x32x16_bf16 v[64:79], v[56:59], v[148:151], v[64:79]
    ds_read_b64_tr_b16 v[52:53], v3 offset:2048
    ds_read_b64_tr_b16 v[54:55], v3 offset:2560
    s_waitcnt lgkmcnt(6)
    buffer_load_dwordx4 v9, s[88:91], s39 offen offset:1024 lds
    v_fma_f32 v23, v23, s49, v47
    v_mul_f32 v111, v103, v111
    v_mul_f32 v16, v16, v96
    v_mul_f32 v17, v17, v97
    v_mul_f32 v18, v18, v98
    v_mul_f32 v19, v19, v99
    v_mfma_f32_32x32x16_bf16 v[64:79], v[60:63], v[152:155], v[64:79]
    ds_read_b64_tr_b16 v[56:57], v3 offset:4096
    ds_read_b64_tr_b16 v[58:59], v3 offset:4608
    s_waitcnt lgkmcnt(6)
    v_mul_f32 v20, v20, v100
    v_mul_f32 v21, v21, v101
    v_mul_f32 v22, v22, v102
    v_mul_f32 v23, v23, v103
    v_exp_f32 v16, v16
    v_mfma_f32_32x32x16_bf16 v[64:79], v[248:251], v[156:159], v[64:79]
    ds_read_b64_tr_b16 v[60:61], v3 offset:6144
    ds_read_b64_tr_b16 v[62:63], v3 offset:6656
    s_waitcnt lgkmcnt(6)
    v_exp_f32 v17, v17
    v_exp_f32 v18, v18
    v_add_f32 v16, 1.0, v16
    v_mfma_f32_32x32x16_bf16 v[64:79], v[48:51], v[160:163], v[64:79]
    ds_read_b64_tr_b16 v[248:249], v3 offset:8192
    ds_read_b64_tr_b16 v[250:251], v3 offset:8704
    s_waitcnt lgkmcnt(6)
    v_exp_f32 v19, v19
    v_add_f32 v17, 1.0, v17
    v_exp_f32 v20, v20
    v_add_f32 v18, 1.0, v18
    v_mfma_f32_32x32x16_bf16 v[64:79], v[52:55], v[164:167], v[64:79]
    ds_read_b64_tr_b16 v[48:49], v3 offset:10240
    ds_read_b64_tr_b16 v[50:51], v3 offset:10752
    s_waitcnt lgkmcnt(6)
    v_exp_f32 v21, v21
    v_add_f32 v19, 1.0, v19
    v_exp_f32 v22, v22
    v_add_f32 v20, 1.0, v20
    v_mfma_f32_32x32x16_bf16 v[64:79], v[56:59], v[168:171], v[64:79]
    ds_read_b64_tr_b16 v[52:53], v3 offset:12288
    ds_read_b64_tr_b16 v[54:55], v3 offset:12800
    s_waitcnt lgkmcnt(6)
    v_exp_f32 v23, v23
    v_add_f32 v21, 1.0, v21
    v_add_f32 v22, 1.0, v22
    v_add_f32 v23, 1.0, v23
    s_barrier
    s_cmp_lg_u32 s3, 0
    s_cbranch_scc1 L_w085
    buffer_load_dword v252, off, s[20:23], s81 sc1
L_w085:
    v_mfma_f32_32x32x16_bf16 v[64:79], v[60:63], v[172:175], v[64:79]
    ds_read_b64_tr_b16 v[56:57], v3 offset:14336
    ds_read_b64_tr_b16 v[58:59], v3 offset:14848
    s_waitcnt lgkmcnt(6)
    s_mul_i32 s39, s58, 286720
    s_mul_i32 m0, s85, 401408
    s_add_u32 s39, s39, m0
    s_add_u32 s39, s39, 57344
    s_add_u32 m0, s40, 49152
    s_nop 0
    buffer_load_dwordx4 v8, s[88:91], s39 offen lds
    v_rcp_f32 v16, v16
    v_rcp_f32 v17, v17
    v_and_b32 v3, 82048, v45
    v_or_b32 v3, v3, v46
    v_mfma_f32_32x32x16_bf16 v[64:79], v[248:251], v[176:179], v[64:79]
    ds_read_b64_tr_b16 v[60:61], v3
    ds_read_b64_tr_b16 v[62:63], v3 offset:512
    s_waitcnt lgkmcnt(6)
    v_rcp_f32 v18, v18
    v_mul_f32 v104, v104, v16
    v_rcp_f32 v19, v19
    v_mul_f32 v105, v105, v17
    v_mfma_f32_32x32x16_bf16 v[64:79], v[48:51], v[180:183], v[64:79]
    ds_read_b64_tr_b16 v[248:249], v3 offset:2048
    ds_read_b64_tr_b16 v[250:251], v3 offset:2560
    s_waitcnt lgkmcnt(6)
    buffer_load_dwordx4 v9, s[88:91], s39 offen offset:1024 lds
    v_rcp_f32 v20, v20
    v_mul_f32 v106, v106, v18
    v_rcp_f32 v21, v21
    v_mul_f32 v107, v107, v19
    v_mfma_f32_32x32x16_bf16 v[64:79], v[52:55], v[184:187], v[64:79]
    ds_read_b64_tr_b16 v[48:49], v3 offset:4096
    ds_read_b64_tr_b16 v[50:51], v3 offset:4608
    s_waitcnt lgkmcnt(6)
    v_rcp_f32 v22, v22
    v_mul_f32 v108, v108, v20
    v_rcp_f32 v23, v23
    v_mul_f32 v109, v109, v21
    v_mfma_f32_32x32x16_bf16 v[64:79], v[56:59], v[188:191], v[64:79]
    ds_read_b64_tr_b16 v[52:53], v3 offset:6144
    ds_read_b64_tr_b16 v[54:55], v3 offset:6656
    s_waitcnt lgkmcnt(6)
    v_mul_f32 v110, v110, v22
    v_mul_f32 v111, v111, v23
    v_cvt_pk_bf16_f32 v100, v104, v105
    v_cvt_pk_bf16_f32 v101, v106, v107
    v_cvt_pk_bf16_f32 v102, v108, v109
    v_cvt_pk_bf16_f32 v103, v110, v111
    v_mfma_f32_32x32x16_bf16 v[64:79], v[60:63], v[192:195], v[64:79]
    ds_read_b64_tr_b16 v[56:57], v3 offset:8192
    ds_read_b64_tr_b16 v[58:59], v3 offset:8704
    s_waitcnt lgkmcnt(6)
    buffer_store_dwordx4 v[100:103], v7, s[20:23], s59 offen sc1
    v_mul_f32 v16, v112, v112
    v_mul_f32 v17, v113, v113
    v_mul_f32 v18, v114, v114
    v_mul_f32 v19, v115, v115
    v_mul_f32 v20, v116, v116
    v_mfma_f32_32x32x16_bf16 v[64:79], v[248:251], v[196:199], v[64:79]
    ds_read_b64_tr_b16 v[60:61], v3 offset:10240
    ds_read_b64_tr_b16 v[62:63], v3 offset:10752
    s_waitcnt lgkmcnt(6)
    v_mul_f32 v21, v117, v117
    v_mul_f32 v22, v118, v118
    v_mul_f32 v23, v119, v119
    v_fma_f32 v16, v16, s49, v47
    v_mul_f32 v120, v112, v120
    v_fma_f32 v17, v17, s49, v47
    v_mfma_f32_32x32x16_bf16 v[64:79], v[48:51], v[200:203], v[64:79]
    ds_read_b64_tr_b16 v[248:249], v3 offset:12288
    ds_read_b64_tr_b16 v[250:251], v3 offset:12800
    s_waitcnt lgkmcnt(6)
    v_mul_f32 v121, v113, v121
    v_fma_f32 v18, v18, s49, v47
    v_mul_f32 v122, v114, v122
    v_fma_f32 v19, v19, s49, v47
    v_mul_f32 v123, v115, v123
    v_fma_f32 v20, v20, s49, v47
    s_cmp_lg_u32 s3, 0
    s_cbranch_scc1 L_w088
    s_waitcnt vmcnt(3)
    s_mov_b32 s73, 0
L_sp86:
    v_readfirstlane_b32 s43, v252
    s_nop 1
    s_and_b32 s43, s43, 0xff
    s_cmp_eq_u32 s43, 0x8
    s_cbranch_scc1 L_ok87
    s_add_u32 s73, s73, 1
    s_cmp_gt_u32 s73, 100000
    s_cbranch_scc1 L_ok87
    s_sleep 2
    buffer_load_dword v252, off, s[20:23], s81 sc1
    s_waitcnt vmcnt(0)
    s_branch L_sp86
L_ok87:
L_w088:
    s_barrier
    v_mfma_f32_32x32x16_bf16 v[64:79], v[52:55], v[204:207], v[64:79]
    ds_read_b64_tr_b16 v[48:49], v3 offset:14336
    ds_read_b64_tr_b16 v[50:51], v3 offset:14848
    s_waitcnt lgkmcnt(6)
    s_mul_i32 s69, s70, 20480
    s_mul_i32 s74, s84, 28672
    s_add_u32 s69, s69, s74
    s_add_u32 s69, s69, 32768
    buffer_load_dwordx4 v[128:131], v6, s[20:23], s69 offen sc1
    v_mul_f32 v124, v116, v124
    v_fma_f32 v21, v21, s49, v47
    v_mul_f32 v125, v117, v125
    v_fma_f32 v22, v22, s49, v47
    v_and_b32 v3, 98496, v45
    v_or_b32 v3, v3, v46
    v_mfma_f32_32x32x16_bf16 v[64:79], v[56:59], v[208:211], v[64:79]
    ds_read_b64_tr_b16 v[52:53], v3
    ds_read_b64_tr_b16 v[54:55], v3 offset:512
    s_waitcnt lgkmcnt(6)
    v_mul_f32 v126, v118, v126
    v_fma_f32 v23, v23, s49, v47
    v_mul_f32 v127, v119, v127
    v_mul_f32 v16, v16, v112
    v_mul_f32 v17, v17, v113
    v_mul_f32 v18, v18, v114
    v_mfma_f32_32x32x16_bf16 v[64:79], v[60:63], v[212:215], v[64:79]
    ds_read_b64_tr_b16 v[56:57], v3 offset:2048
    ds_read_b64_tr_b16 v[58:59], v3 offset:2560
    s_waitcnt lgkmcnt(6)
    buffer_load_dwordx4 v[132:135], v6, s[20:23], s69 offen offset:1024 sc1
    v_mul_f32 v19, v19, v115
    v_mul_f32 v20, v20, v116
    v_mul_f32 v21, v21, v117
    v_mul_f32 v22, v22, v118
    v_mul_f32 v23, v23, v119
    v_mfma_f32_32x32x16_bf16 v[64:79], v[248:251], v[216:219], v[64:79]
    ds_read_b64_tr_b16 v[60:61], v3 offset:4096
    ds_read_b64_tr_b16 v[62:63], v3 offset:4608
    s_waitcnt lgkmcnt(6)
    v_exp_f32 v16, v16
    v_exp_f32 v17, v17
    v_exp_f32 v18, v18
    v_mfma_f32_32x32x16_bf16 v[64:79], v[48:51], v[220:223], v[64:79]
    ds_read_b64_tr_b16 v[248:249], v3 offset:6144
    ds_read_b64_tr_b16 v[250:251], v3 offset:6656
    s_waitcnt lgkmcnt(6)
    s_mul_i32 s69, s70, 20480
    s_mul_i32 s74, s85, 28672
    s_add_u32 s69, s69, s74
    s_add_u32 s69, s69, 32768
    buffer_load_dwordx4 v[136:139], v6, s[20:23], s69 offen sc1
    v_add_f32 v16, 1.0, v16
    v_exp_f32 v19, v19
    v_add_f32 v17, 1.0, v17
    v_or_b32 v3, 114688, v14
    v_xor_b32 v4, 114752, v14
    s_barrier
    v_mfma_f32_32x32x16_bf16 v[64:79], v[52:55], v[224:227], v[64:79]
    ds_read_b64_tr_b16 v[48:49], v3
    ds_read_b64_tr_b16 v[50:51], v3 offset:1024
    s_waitcnt lgkmcnt(6)
    v_exp_f32 v20, v20
    v_add_f32 v18, 1.0, v18
    v_exp_f32 v21, v21
    v_add_f32 v19, 1.0, v19
    v_mfma_f32_32x32x16_bf16 v[64:79], v[56:59], v[228:231], v[64:79]
    ds_read_b64_tr_b16 v[52:53], v4
    ds_read_b64_tr_b16 v[54:55], v4 offset:1024
    s_waitcnt lgkmcnt(6)
    buffer_load_dwordx4 v[140:143], v6, s[20:23], s69 offen offset:1024 sc1
    v_exp_f32 v22, v22
    v_add_f32 v20, 1.0, v20
    v_exp_f32 v23, v23
    v_add_f32 v21, 1.0, v21
    v_mfma_f32_32x32x16_bf16 v[64:79], v[60:63], v[232:235], v[64:79]
    ds_read_b64_tr_b16 v[56:57], v3 offset:2048
    ds_read_b64_tr_b16 v[58:59], v3 offset:3072
    s_waitcnt lgkmcnt(6)
    v_add_f32 v22, 1.0, v22
    v_add_f32 v23, 1.0, v23
    v_rcp_f32 v16, v16
    v_rcp_f32 v17, v17
    v_mfma_f32_32x32x16_bf16 v[64:79], v[248:251], v[236:239], v[64:79]
    ds_read_b64_tr_b16 v[60:61], v4 offset:2048
    ds_read_b64_tr_b16 v[62:63], v4 offset:3072
    s_waitcnt lgkmcnt(6)
    s_mul_i32 s69, s70, 20480
    s_mul_i32 s74, s86, 28672
    s_add_u32 s69, s69, s74
    s_add_u32 s69, s69, 32768
    buffer_load_dwordx4 v[144:147], v6, s[20:23], s69 offen sc1
    v_rcp_f32 v18, v18
    v_mul_f32 v120, v120, v16
    v_or_b32 v3, 131072, v14
    v_xor_b32 v4, 131136, v14
    s_waitcnt vmcnt(14)
    s_barrier
    s_waitcnt vmcnt(4)
    v_mfma_f32_32x32x16_bf16 v[160:175], v[48:51], v[128:131], 0
    ds_read_b64_tr_b16 v[248:249], v3
    ds_read_b64_tr_b16 v[250:251], v3 offset:1024
    s_waitcnt lgkmcnt(6)
    buffer_load_dwordx4 v[148:151], v6, s[20:23], s69 offen offset:1024 sc1
    v_rcp_f32 v19, v19
    v_mul_f32 v121, v121, v17
    v_rcp_f32 v20, v20
    v_mul_f32 v122, v122, v18
    v_rcp_f32 v21, v21
    v_mul_f32 v123, v123, v19
    v_rcp_f32 v22, v22
    v_mul_f32 v124, v124, v20
    s_mul_i32 s69, s70, 20480
    s_mul_i32 s74, s87, 28672
    s_add_u32 s69, s69, s74
    s_add_u32 s69, s69, 32768
    buffer_load_dwordx4 v[152:155], v6, s[20:23], s69 offen sc1
    v_rcp_f32 v23, v23
    v_mul_f32 v125, v125, v21
    v_mul_f32 v126, v126, v22
    v_mul_f32 v127, v127, v23
    v_cvt_pk_bf16_f32 v112, v120, v121
    v_cvt_pk_bf16_f32 v113, v122, v123
    v_cvt_pk_bf16_f32 v114, v124, v125
    v_cvt_pk_bf16_f32 v115, v126, v127
    buffer_store_dwordx4 v[112:115], v7, s[20:23], s59 offen offset:1024 sc1
    v_mfma_f32_32x32x16_bf16 v[176:191], v[52:55], v[128:131], 0
    ds_read_b64_tr_b16 v[48:49], v4
    ds_read_b64_tr_b16 v[50:51], v4 offset:1024
    s_waitcnt lgkmcnt(6)
    buffer_load_dwordx4 v[156:159], v6, s[20:23], s69 offen offset:1024 sc1
    v_mov_b32 v32, v76
    v_mov_b32 v33, v76
    v_cvt_pk_bf16_f32 v16, v64, v65
    v_cvt_pk_bf16_f32 v17, v66, v67
    v_cvt_pk_bf16_f32 v18, v68, v69
    v_cvt_pk_bf16_f32 v19, v70, v71
    v_cvt_pk_bf16_f32 v20, v72, v73
    v_cvt_pk_bf16_f32 v21, v74, v75
    v_cvt_pk_bf16_f32 v22, v76, v77
    v_cvt_pk_bf16_f32 v23, v78, v79
    v_permlane32_swap_b32 v32, v33
    v_mfma_f32_32x32x16_bf16 v[64:79], v[240:243], v[16:19], 0
    v_mfma_f32_32x32x16_bf16 v[64:79], v[244:247], v[20:23], v[64:79]
    v_mul_f32 v33, s48, v33
    s_mul_i32 s39, s58, 286720
    s_mul_i32 m0, s86, 401408
    s_add_u32 s39, s39, m0
    s_add_u32 s39, s39, 57344
    s_add_u32 m0, s40, 65536
    s_nop 0
    buffer_load_dwordx4 v8, s[88:91], s39 offen lds
    v_exp_f32 v32, v33
    v_exp_f32_e64 v33, -v33
    v_and_b32 v41, 31, v1
    v_lshlrev_b32 v41, 2, v41
    v_add_f32 v32, 1.0, v32
    v_add_f32 v33, 1.0, v33
    v_rcp_f32 v40, v32
    v_rcp_f32 v15, v33
    v_max3_f32 v32, v64, v65, v66
    buffer_load_dwordx4 v9, s[88:91], s39 offen offset:1024 lds
    s_or_b32 s43, s5, s58
    s_cmp_lg_u32 s43, 0
    s_cbranch_scc1 L_gs94
    buffer_store_dword v40, v41, s[20:23], s76 offen sc1
L_gs94:
    s_waitcnt vmcnt(9)
    v_mfma_f32_32x32x16_bf16 v[160:175], v[56:59], v[132:135], v[160:175]
    ds_read_b64_tr_b16 v[52:53], v3 offset:2048
    ds_read_b64_tr_b16 v[54:55], v3 offset:3072
    s_waitcnt lgkmcnt(6)
    s_mul_i32 s39, s58, 286720
    s_mul_i32 m0, s87, 401408
    s_add_u32 s39, s39, m0
    s_add_u32 s39, s39, 57344
    s_add_u32 m0, s40, 81920
    s_nop 0
    buffer_load_dwordx4 v8, s[88:91], s39 offen lds
    v_min3_f32 v33, v64, v65, v66
    v_max3_f32 v32, v32, v67, v68
    v_min3_f32 v33, v33, v67, v68
    v_max3_f32 v32, v32, v69, v70
    v_min3_f32 v33, v33, v69, v70
    v_max3_f32 v32, v32, v71, v72
    v_min3_f32 v33, v33, v71, v72
    v_max3_f32 v32, v32, v73, v74
    v_min3_f32 v33, v33, v73, v74
    v_max3_f32 v32, v32, v75, v76
    v_min3_f32 v33, v33, v75, v76
    v_max3_f32 v32, v32, v77, v78
    buffer_load_dwordx4 v9, s[88:91], s39 offen offset:1024 lds
    v_min3_f32 v33, v33, v77, v78
    v_max_f32 v34, v32, v79
    v_mfma_f32_32x32x16_bf16 v[176:191], v[60:63], v[132:135], v[176:191]
    ds_read_b64_tr_b16 v[56:57], v4 offset:2048
    ds_read_b64_tr_b16 v[58:59], v4 offset:3072
    s_waitcnt lgkmcnt(6)
    s_mul_i32 s39, s58, 114688
    s_mul_i32 m0, s84, 401408
    s_add_u32 s39, s39, m0
    s_add_u32 s39, s39, 114688
    s_add_u32 m0, s40, 98304
    s_nop 0
    buffer_load_dwordx4 v8, s[88:91], s39 offen lds
    v_min_f32 v38, v33, v79
    v_max_f32 v35, v32, v79
    v_min_f32 v39, v33, v79
    v_mul_f32 v64, s48, v64
    v_mul_f32 v65, s48, v65
    v_permlane32_swap_b32 v34, v35
    v_permlane32_swap_b32 v38, v39
    v_mul_f32 v66, s48, v66
    v_mul_f32 v67, s48, v67
    v_max_f32 v32, v34, v35
    buffer_load_dwordx4 v9, s[88:91], s39 offen offset:1024 lds
    v_or_b32 v3, 0, v14
    v_xor_b32 v4, 64, v14
    s_barrier
    s_cmp_lg_u32 s3, 0
    s_cbranch_scc1 L_w095
    buffer_load_dword v253, off, s[20:23], s82 sc1
L_w095:
    s_waitcnt vmcnt(12)
    v_mfma_f32_32x32x16_bf16 v[160:175], v[248:251], v[136:139], v[160:175]
    ds_read_b64_tr_b16 v[60:61], v3
    ds_read_b64_tr_b16 v[62:63], v3 offset:1024
    s_waitcnt lgkmcnt(6)
    s_mul_i32 s39, s58, 114688
    s_mul_i32 m0, s85, 401408
    s_add_u32 s39, s39, m0
    s_add_u32 s39, s39, 114688
    s_add_u32 m0, s40, 114688
    s_nop 0
    buffer_load_dwordx4 v8, s[88:91], s39 offen lds
    v_min_f32 v33, v38, v39
    v_mul_f32 v32, s48, v32
    v_mul_f32 v33, s48, v33
    v_sub_f32 v80, v33, v64
    v_sub_f32 v64, v64, v32
    v_sub_f32 v81, v33, v65
    v_sub_f32 v65, v65, v32
    v_sub_f32 v82, v33, v66
    v_sub_f32 v66, v66, v32
    v_exp_f32 v80, v80
    v_exp_f32 v64, v64
    v_sub_f32 v83, v33, v67
    buffer_load_dwordx4 v9, s[88:91], s39 offen offset:1024 lds
    v_mfma_f32_32x32x16_bf16 v[176:191], v[48:51], v[136:139], v[176:191]
    ds_read_b64_tr_b16 v[248:249], v4
    ds_read_b64_tr_b16 v[250:251], v4 offset:1024
    s_waitcnt lgkmcnt(6)
    v_sub_f32 v67, v67, v32
    v_exp_f32 v81, v81
    v_exp_f32 v65, v65
    v_fma_f32 v84, v68, -s48, v33
    v_fma_f32 v68, v68, s48, -v32
    v_exp_f32 v82, v82
    v_exp_f32 v66, v66
    v_fma_f32 v85, v69, -s48, v33
    v_fma_f32 v69, v69, s48, -v32
    s_waitcnt vmcnt(13)
    v_mfma_f32_32x32x16_bf16 v[160:175], v[52:55], v[140:143], v[160:175]
    ds_read_b64_tr_b16 v[48:49], v3 offset:2048
    ds_read_b64_tr_b16 v[50:51], v3 offset:3072
    s_waitcnt lgkmcnt(6)
    v_exp_f32 v83, v83
    v_exp_f32 v67, v67
    v_add_f32 v37, v80, v81
    v_add_f32 v36, v64, v65
    v_fma_f32 v86, v70, -s48, v33
    v_fma_f32 v70, v70, s48, -v32
    v_exp_f32 v84, v84
    v_exp_f32 v68, v68
    v_add_f32 v37, v37, v82
    v_add_f32 v36, v36, v66
    v_mfma_f32_32x32x16_bf16 v[176:191], v[56:59], v[140:143], v[176:191]
    ds_read_b64_tr_b16 v[52:53], v4 offset:2048
    ds_read_b64_tr_b16 v[54:55], v4 offset:3072
    s_waitcnt lgkmcnt(6)
    v_fma_f32 v87, v71, -s48, v33
    v_fma_f32 v71, v71, s48, -v32
    v_exp_f32 v85, v85
    v_exp_f32 v69, v69
    v_add_f32 v37, v37, v83
    v_add_f32 v36, v36, v67
    v_fma_f32 v88, v72, -s48, v33
    v_fma_f32 v72, v72, s48, -v32
    v_exp_f32 v86, v86
    v_or_b32 v3, 16384, v14
    v_xor_b32 v4, 16448, v14
    s_cmp_lg_u32 s3, 0
    s_cbranch_scc1 L_w098
    s_waitcnt vmcnt(2)
    s_mov_b32 s73, 0
L_sp96:
    v_readfirstlane_b32 s43, v253
    s_nop 1
    s_and_b32 s43, s43, 0xffff
    s_cmp_eq_u32 s43, 0x1010
    s_cbranch_scc1 L_ok97
    s_add_u32 s73, s73, 1
    s_cmp_gt_u32 s73, 100000
    s_cbranch_scc1 L_ok97
    s_sleep 2
    buffer_load_dword v253, off, s[20:23], s82 sc1
    s_waitcnt vmcnt(0)
    s_branch L_sp96
L_ok97:
L_w098:
    s_barrier
    v_and_b32 v97, 7, v1
    v_lshlrev_b32 v97, 4, v97
    v_lshrrev_b32 v96, 3, v1
    v_lshl_add_u32 v96, v96, 14, v97
    buffer_load_dwordx4 v[224:227], v96, s[20:23], s66 offen sc1
    s_add_u32 s71, s66, 131072
    buffer_load_dwordx4 v[228:231], v96, s[20:23], s71 offen sc1
    s_waitcnt vmcnt(14)
    v_mfma_f32_32x32x16_bf16 v[160:175], v[60:63], v[144:147], v[160:175]
    ds_read_b64_tr_b16 v[56:57], v3
    ds_read_b64_tr_b16 v[58:59], v3 offset:1024
    s_waitcnt lgkmcnt(6)
    s_mul_i32 s69, s70, 20480
    s_mul_i32 s74, s84, 28672
    s_add_u32 s69, s69, s74
    s_add_u32 s69, s69, 36864
    buffer_load_dwordx4 v[192:195], v6, s[20:23], s69 offen sc1
    v_exp_f32 v70, v70
    v_add_f32 v37, v37, v84
    v_add_f32 v36, v36, v68
    v_fma_f32 v89, v73, -s48, v33
    v_fma_f32 v73, v73, s48, -v32
    v_exp_f32 v87, v87
    v_exp_f32 v71, v71
    v_add_f32 v37, v37, v85
    v_add_f32 v36, v36, v69
    buffer_load_dwordx4 v[196:199], v6, s[20:23], s69 offen offset:1024 sc1
    v_fma_f32 v90, v74, -s48, v33
    v_fma_f32 v74, v74, s48, -v32
    v_mfma_f32_32x32x16_bf16 v[176:191], v[248:251], v[144:147], v[176:191]
    ds_read_b64_tr_b16 v[60:61], v4
    ds_read_b64_tr_b16 v[62:63], v4 offset:1024
    s_waitcnt lgkmcnt(6)
    s_mul_i32 s69, s70, 20480
    s_mul_i32 s74, s85, 28672
    s_add_u32 s69, s69, s74
    s_add_u32 s69, s69, 36864
    buffer_load_dwordx4 v[200:203], v6, s[20:23], s69 offen sc1
    v_exp_f32 v88, v88
    v_exp_f32 v72, v72
    v_add_f32 v37, v37, v86
    v_add_f32 v36, v36, v70
    v_fma_f32 v91, v75, -s48, v33
    v_fma_f32 v75, v75, s48, -v32
    v_exp_f32 v89, v89
    v_exp_f32 v73, v73
    v_add_f32 v37, v37, v87
    buffer_load_dwordx4 v[204:207], v6, s[20:23], s69 offen offset:1024 sc1
    v_add_f32 v36, v36, v71
    s_waitcnt vmcnt(17)
    v_mfma_f32_32x32x16_bf16 v[160:175], v[48:51], v[148:151], v[160:175]
    ds_read_b64_tr_b16 v[248:249], v3 offset:2048
    ds_read_b64_tr_b16 v[250:251], v3 offset:3072
    s_waitcnt lgkmcnt(6)
    s_mul_i32 s69, s70, 20480
    s_mul_i32 s74, s86, 28672
    s_add_u32 s69, s69, s74
    s_add_u32 s69, s69, 36864
    buffer_load_dwordx4 v[208:211], v6, s[20:23], s69 offen sc1
    v_fma_f32 v92, v76, -s48, v33
    v_fma_f32 v76, v76, s48, -v32
    v_exp_f32 v90, v90
    v_exp_f32 v74, v74
    v_add_f32 v37, v37, v88
    v_add_f32 v36, v36, v72
    v_fma_f32 v93, v77, -s48, v33
    v_fma_f32 v77, v77, s48, -v32
    v_exp_f32 v91, v91
    v_exp_f32 v75, v75
    v_mfma_f32_32x32x16_bf16 v[176:191], v[52:55], v[148:151], v[176:191]
    ds_read_b64_tr_b16 v[48:49], v4 offset:2048
    ds_read_b64_tr_b16 v[50:51], v4 offset:3072
    s_waitcnt lgkmcnt(6)
    buffer_load_dwordx4 v[212:215], v6, s[20:23], s69 offen offset:1024 sc1
    v_add_f32 v37, v37, v89
    v_add_f32 v36, v36, v73
    v_fma_f32 v94, v78, -s48, v33
    v_fma_f32 v78, v78, s48, -v32
    v_exp_f32 v92, v92
    v_exp_f32 v76, v76
    v_add_f32 v37, v37, v90
    v_add_f32 v36, v36, v74
    v_fma_f32 v95, v79, -s48, v33
    v_fma_f32 v79, v79, s48, -v32
    s_mul_i32 s69, s70, 20480
    s_mul_i32 s74, s87, 28672
    s_add_u32 s69, s69, s74
    s_add_u32 s69, s69, 36864
    buffer_load_dwordx4 v[216:219], v6, s[20:23], s69 offen sc1
    v_or_b32 v3, 32768, v14
    v_xor_b32 v4, 32832, v14
    s_barrier
    s_cmp_lg_u32 s3, 0
    s_cbranch_scc1 L_w089
    buffer_load_dword v252, off, s[20:23], s81 sc1
L_w089:
    s_waitcnt vmcnt(19)
    v_mfma_f32_32x32x16_bf16 v[160:175], v[56:59], v[152:155], v[160:175]
    ds_read_b64_tr_b16 v[52:53], v3
    ds_read_b64_tr_b16 v[54:55], v3 offset:1024
    s_waitcnt lgkmcnt(6)
    buffer_load_dwordx4 v[220:223], v6, s[20:23], s69 offen offset:1024 sc1
    v_exp_f32 v93, v93
    v_exp_f32 v77, v77
    v_add_f32 v37, v37, v91
    v_add_f32 v36, v36, v75
    v_exp_f32 v94, v94
    v_exp_f32 v78, v78
    v_add_f32 v38, v92, v93
    v_add_f32 v34, v76, v77
    s_mul_i32 s39, s58, 114688
    s_mul_i32 m0, s86, 401408
    s_add_u32 s39, s39, m0
    s_add_u32 s39, s39, 114688
    s_add_u32 m0, s40, 131072
    s_nop 0
    buffer_load_dwordx4 v8, s[88:91], s39 offen lds
    v_exp_f32 v95, v95
    v_mfma_f32_32x32x16_bf16 v[176:191], v[60:63], v[152:155], v[176:191]
    ds_read_b64_tr_b16 v[56:57], v4
    ds_read_b64_tr_b16 v[58:59], v4 offset:1024
    s_waitcnt lgkmcnt(6)
    buffer_load_dwordx4 v9, s[88:91], s39 offen offset:1024 lds
    v_exp_f32 v79, v79
    v_add_f32 v38, v38, v94
    s_waitcnt vmcnt(20)
    v_mfma_f32_32x32x16_bf16 v[160:175], v[248:251], v[156:159], v[160:175]
    ds_read_b64_tr_b16 v[60:61], v3 offset:2048
    ds_read_b64_tr_b16 v[62:63], v3 offset:3072
    s_waitcnt lgkmcnt(6)
    s_mul_i32 s39, s58, 114688
    s_mul_i32 m0, s87, 401408
    s_add_u32 s39, s39, m0
    s_add_u32 s39, s39, 114688
    s_add_u32 m0, s40, 0
    s_nop 0
    buffer_load_dwordx4 v8, s[88:91], s39 offen lds
    s_waitcnt vmcnt(11)
    v_add_f32 v224, v224, v228
    v_add_f32 v225, v225, v229
    v_add_f32 v226, v226, v230
    v_add_f32 v227, v227, v231
    s_nop 0
    v_add_f32_dpp v224, v224, v224 row_ror:8 row_mask:0xf bank_mask:0xf
    v_add_f32_dpp v225, v225, v225 row_ror:8 row_mask:0xf bank_mask:0xf
    v_add_f32_dpp v226, v226, v226 row_ror:8 row_mask:0xf bank_mask:0xf
    v_add_f32_dpp v227, v227, v227 row_ror:8 row_mask:0xf bank_mask:0xf
    v_mov_b32 v228, v224
    v_mov_b32 v229, v225
    v_mov_b32 v230, v226
    buffer_load_dwordx4 v9, s[88:91], s39 offen offset:1024 lds
    v_mov_b32 v231, v227
    v_permlane16_swap_b32 v224, v228
    v_permlane16_swap_b32 v225, v229
    v_permlane16_swap_b32 v226, v230
    v_permlane16_swap_b32 v227, v231
    v_add_f32 v224, v224, v228
    v_add_f32 v225, v225, v229
    v_add_f32 v226, v226, v230
    v_add_f32 v227, v227, v231
    v_mov_b32 v228, v224
    v_mov_b32 v229, v225
    v_mov_b32 v230, v226
    v_mov_b32 v231, v227
    v_permlane32_swap_b32 v224, v228
    v_permlane32_swap_b32 v225, v229
    v_permlane32_swap_b32 v226, v230
    v_permlane32_swap_b32 v227, v231
    v_add_f32 v224, v224, v228
    v_add_f32 v225, v225, v229
    v_add_f32 v226, v226, v230
    v_add_f32 v227, v227, v231
    v_cvt_pk_bf16_f32 v228, v224, v225
    v_cvt_pk_bf16_f32 v229, v226, v227
    v_and_b32 v228, s78, v228
    v_and_b32 v229, s78, v229
    s_mov_b64 exec, 0xff
    buffer_store_dwordx2 v[228:229], v97, s[20:23], s67 offen sc1
    s_mov_b64 exec, -1
    v_mfma_f32_32x32x16_bf16 v[176:191], v[48:51], v[156:159], v[176:191]
    ds_read_b64_tr_b16 v[248:249], v4 offset:2048
    ds_read_b64_tr_b16 v[250:251], v4 offset:3072
    s_waitcnt lgkmcnt(6)
    v_add_f32 v34, v34, v78
    v_add_f32 v38, v38, v95
    v_add_f32 v34, v34, v79
    v_fma_f32 v39, v38, v42, v37
    v_fma_f32 v35, v34, v42, v36
    v_fma_f32 v38, v38, v42, v37
    v_fma_f32 v34, v34, v42, v36
    s_nop 0
    v_permlane32_swap_b32 v38, v39
    v_permlane32_swap_b32 v34, v35
    v_or_b32 v3, 49152, v14
    v_xor_b32 v4, 49216, v14
    s_barrier
    s_waitcnt vmcnt(11)
    v_max3_u32 v254, v192, v195, v196
    v_max_u32 v254, v254, v199
    v_cmp_eq_u32 vcc, -1, v254
    s_cbranch_vccnz L_retry108
L_back109:
    v_mfma_f32_32x32x16_bf16 v[160:175], v[52:55], v[192:195], v[160:175]
    ds_read_b64_tr_b16 v[48:49], v3
    ds_read_b64_tr_b16 v[50:51], v3 offset:1024
    s_waitcnt lgkmcnt(6)
    s_mul_i32 s39, s58, 401408
    s_mul_i32 m0, s64, 802816
    s_add_u32 s39, s39, m0
    s_add_u32 s39, s39, 172032
    s_add_u32 m0, s40, 16384
    s_nop 0
    buffer_load_dwordx4 v8, s[88:91], s39 offen lds
    v_add_f32 v37, v38, v39
    v_add_f32 v36, v34, v35
    v_rcp_f32 v36, v36
    v_rcp_f32 v37, v37
    v_mul_f32 v64, v64, v36
    v_mul_f32 v65, v65, v36
    v_mul_f32 v66, v66, v36
    v_mul_f32 v67, v67, v36
    v_mul_f32 v68, v68, v36
    v_mul_f32 v69, v69, v36
    buffer_load_dwordx4 v9, s[88:91], s39 offen offset:1024 lds
    v_mul_f32 v70, v70, v36
    v_mul_f32 v71, v71, v36
    v_mfma_f32_32x32x16_bf16 v[176:191], v[56:59], v[192:195], v[176:191]
    ds_read_b64_tr_b16 v[52:53], v4
    ds_read_b64_tr_b16 v[54:55], v4 offset:1024
    s_waitcnt lgkmcnt(6)
    v_mul_f32 v72, v72, v36
    v_mul_f32 v73, v73, v36
    v_mul_f32 v74, v74, v36
    v_mul_f32 v75, v75, v36
    v_mul_f32 v76, v76, v36
    v_mul_f32 v77, v77, v36
    v_mul_f32 v78, v78, v36
    v_mul_f32 v79, v79, v36
    v_mul_f32 v80, v80, v37
    v_mul_f32 v81, v81, v37
    v_cvt_pk_bf16_f32 v16, v64, v65
    v_mul_f32 v82, v82, v37
    v_mul_f32 v83, v83, v37
    v_cvt_pk_bf16_f32 v17, v66, v67
    v_mfma_f32_32x32x16_bf16 v[160:175], v[60:63], v[196:199], v[160:175]
    ds_read_b64_tr_b16 v[56:57], v3 offset:2048
    ds_read_b64_tr_b16 v[58:59], v3 offset:3072
    s_waitcnt lgkmcnt(6)
    v_mul_f32 v84, v84, v37
    v_mul_f32 v85, v85, v37
    v_cvt_pk_bf16_f32 v18, v68, v69
    v_mul_f32 v86, v86, v37
    v_mul_f32 v87, v87, v37
    v_cvt_pk_bf16_f32 v19, v70, v71
    v_mul_f32 v88, v88, v37
    v_mul_f32 v89, v89, v37
    v_cvt_pk_bf16_f32 v20, v72, v73
    v_mul_f32 v90, v90, v37
    v_mul_f32 v91, v91, v37
    v_cvt_pk_bf16_f32 v21, v74, v75
    v_mul_f32 v92, v92, v37
    v_mul_f32 v93, v93, v37
    v_mfma_f32_32x32x16_bf16 v[176:191], v[248:251], v[196:199], v[176:191]
    ds_read_b64_tr_b16 v[60:61], v4 offset:2048
    ds_read_b64_tr_b16 v[62:63], v4 offset:3072
    s_waitcnt lgkmcnt(6)
    v_cvt_pk_bf16_f32 v22, v76, v77
    v_mul_f32 v94, v94, v37
    v_mul_f32 v95, v95, v37
    v_cvt_pk_bf16_f32 v23, v78, v79
    v_cvt_pk_bf16_f32 v24, v80, v81
    v_cvt_pk_bf16_f32 v25, v82, v83
    v_cvt_pk_bf16_f32 v26, v84, v85
    v_cvt_pk_bf16_f32 v27, v86, v87
    v_cvt_pk_bf16_f32 v28, v88, v89
    v_cvt_pk_bf16_f32 v29, v90, v91
    v_cvt_pk_bf16_f32 v30, v92, v93
    v_cvt_pk_bf16_f32 v31, v94, v95
    v_or_b32 v3, 65536, v14
    v_xor_b32 v4, 65600, v14
    s_cmp_lg_u32 s3, 0
    s_cbranch_scc1 L_w092
    s_waitcnt vmcnt(8)
    s_mov_b32 s73, 0
L_sp90:
    v_readfirstlane_b32 s43, v252
    s_nop 1
    s_and_b32 s43, s43, 0xff00
    s_cmp_eq_u32 s43, 0x800
    s_cbranch_scc1 L_ok91
    s_add_u32 s73, s73, 1
    s_cmp_gt_u32 s73, 100000
    s_cbranch_scc1 L_ok91
    s_sleep 2
    buffer_load_dword v252, off, s[20:23], s81 sc1
    s_waitcnt vmcnt(0)
    s_branch L_sp90
L_ok91:
L_w092:
    s_barrier
    s_waitcnt vmcnt(11)
    v_max3_u32 v254, v200, v203, v204
    v_max_u32 v254, v254, v207
    v_cmp_eq_u32 vcc, -1, v254
    s_cbranch_vccnz L_retry111
L_back112:
    v_mfma_f32_32x32x16_bf16 v[160:175], v[48:51], v[200:203], v[160:175]
    ds_read_b64_tr_b16 v[248:249], v3
    ds_read_b64_tr_b16 v[250:251], v3 offset:1024
    s_waitcnt lgkmcnt(6)
    s_mul_i32 s39, s58, 401408
    s_mul_i32 m0, s65, 802816
    s_add_u32 s39, s39, m0
    s_add_u32 s39, s39, 172032
    s_add_u32 m0, s40, 32768
    s_nop 0
    buffer_load_dwordx4 v8, s[88:91], s39 offen lds
    v_lshlrev_b32 v96, 4, v1
    v_mfma_f32_32x32x16_bf16 v[176:191], v[52:55], v[200:203], v[176:191]
    ds_read_b64_tr_b16 v[48:49], v4
    ds_read_b64_tr_b16 v[50:51], v4 offset:1024
    s_waitcnt lgkmcnt(6)
    buffer_load_dwordx4 v9, s[88:91], s39 offen offset:1024 lds
    buffer_load_dwordx4 v[224:227], v96, s[20:23], s77 offen sc1
    buffer_load_dwordx4 v[228:231], v96, s[20:23], s77 offen offset:1024 sc1
    buffer_load_dwordx4 v[232:235], v96, s[20:23], s77 offen offset:2048 sc1
    buffer_load_dwordx4 v[236:239], v96, s[20:23], s77 offen offset:3072 sc1
    v_mfma_f32_32x32x16_bf16 v[160:175], v[56:59], v[204:207], v[160:175]
    ds_read_b64_tr_b16 v[52:53], v3 offset:2048
    ds_read_b64_tr_b16 v[54:55], v3 offset:3072
    s_waitcnt lgkmcnt(6)
    v_mfma_f32_32x32x16_bf16 v[176:191], v[60:63], v[204:207], v[176:191]
    ds_read_b64_tr_b16 v[56:57], v4 offset:2048
    ds_read_b64_tr_b16 v[58:59], v4 offset:3072
    s_waitcnt lgkmcnt(6)
    v_or_b32 v3, 81920, v14
    v_xor_b32 v4, 81984, v14
    s_barrier
    s_waitcnt vmcnt(15)
    v_max3_u32 v254, v208, v211, v212
    v_max_u32 v254, v254, v215
    v_cmp_eq_u32 vcc, -1, v254
    s_cbranch_vccnz L_retry114
L_back115:
    v_mfma_f32_32x32x16_bf16 v[160:175], v[248:251], v[208:211], v[160:175]
    ds_read_b64_tr_b16 v[60:61], v3
    ds_read_b64_tr_b16 v[62:63], v3 offset:1024
    s_waitcnt lgkmcnt(6)
    s_mul_i32 s69, s70, 8192
    s_mul_i32 s74, s84, 28672
    s_add_u32 s69, s69, s74
    s_add_u32 s69, s69, 40960
    buffer_load_dwordx4 v[128:131], v6, s[20:23], s69 offen sc1
    v_mfma_f32_32x32x16_bf16 v[176:191], v[48:51], v[208:211], v[176:191]
    ds_read_b64_tr_b16 v[248:249], v4
    ds_read_b64_tr_b16 v[250:251], v4 offset:1024
    s_waitcnt lgkmcnt(6)
    buffer_load_dwordx4 v[132:135], v6, s[20:23], s69 offen offset:1024 sc1
    s_waitcnt vmcnt(4)
    v_max3_u32 v98, v224, v226, v228
    s_waitcnt vmcnt(3)
    v_max3_u32 v98, v98, v230, v232
    s_waitcnt vmcnt(2)
    v_max3_u32 v98, v98, v234, v236
    v_max_u32 v98, v98, v238
    v_cmp_eq_u32 vcc, -1, v98
    s_cbranch_vccnz L_retry99
L_back100:
    v_mfma_f32_32x32x16_bf16 v[160:175], v[52:55], v[212:215], v[160:175]
    ds_read_b64_tr_b16 v[48:49], v3 offset:2048
    ds_read_b64_tr_b16 v[50:51], v3 offset:3072
    s_waitcnt lgkmcnt(6)
    s_mul_i32 s69, s70, 8192
    s_mul_i32 s74, s85, 28672
    s_add_u32 s69, s69, s74
    s_add_u32 s69, s69, 40960
    buffer_load_dwordx4 v[136:139], v6, s[20:23], s69 offen sc1
    v_mfma_f32_32x32x16_bf16 v[64:79], v[224:227], v[16:19], 0
    v_mfma_f32_32x32x16_bf16 v[64:79], v[228:231], v[20:23], v[64:79]
    v_mfma_f32_32x32x16_bf16 v[64:79], v[232:235], v[24:27], v[64:79]
    v_mfma_f32_32x32x16_bf16 v[64:79], v[236:239], v[28:31], v[64:79]
    v_mfma_f32_32x32x16_bf16 v[176:191], v[56:59], v[212:215], v[176:191]
    ds_read_b64_tr_b16 v[52:53], v4 offset:2048
    ds_read_b64_tr_b16 v[54:55], v4 offset:3072
    s_waitcnt lgkmcnt(6)
    buffer_load_dwordx4 v[140:143], v6, s[20:23], s69 offen offset:1024 sc1
    s_nop 6
    v_mov_b32 v32, v76
    v_mov_b32 v33, v76
    s_nop 0
    s_nop 0
    v_permlane32_swap_b32 v32, v33
    v_add_f32 v33, 0x358637bd, v33
    v_rcp_f32 v33, v33
    s_nop 0
    v_mul_f32 v33, v33, v15
    v_mul_f32 v32, v33, v42
    v_mul_f32 v64, v64, v33
    s_mul_i32 s69, s70, 8192
    s_mul_i32 s74, s86, 28672
    s_add_u32 s69, s69, s74
    s_add_u32 s69, s69, 40960
    buffer_load_dwordx4 v[144:147], v6, s[20:23], s69 offen sc1
    v_mul_f32 v65, v65, v33
    v_mul_f32 v66, v66, v33
    v_mul_f32 v67, v67, v33
    v_mul_f32 v68, v68, v33
    v_mul_f32 v69, v69, v33
    v_mul_f32 v70, v70, v33
    v_mul_f32 v71, v71, v33
    v_mul_f32 v72, v72, v33
    v_mul_f32 v73, v73, v33
    v_mul_f32 v74, v74, v33
    v_mul_f32 v75, v75, v33
    v_mul_f32 v76, v76, v32
    buffer_load_dwordx4 v[148:151], v6, s[20:23], s69 offen offset:1024 sc1
    v_mul_f32 v77, v77, v32
    v_mul_f32 v78, v78, v32
    v_mul_f32 v79, v79, v32
    v_cvt_pk_bf16_f32 v16, v64, v65
    v_cvt_pk_bf16_f32 v17, v66, v67
    v_cvt_pk_bf16_f32 v18, v68, v69
    v_cvt_pk_bf16_f32 v19, v70, v71
    v_cvt_pk_bf16_f32 v20, v72, v73
    v_cvt_pk_bf16_f32 v21, v74, v75
    v_cvt_pk_bf16_f32 v22, v76, v77
    v_cvt_pk_bf16_f32 v23, v78, v79
    buffer_store_dwordx4 v[16:19], v7, s[20:23], s68 offen sc1
    buffer_store_dwordx4 v[20:23], v7, s[20:23], s68 offen offset:1024 sc1
    v_or_b32 v3, 98304, v14
    v_xor_b32 v4, 98368, v14
    s_barrier
    v_max3_u32 v254, v216, v219, v220
    v_max_u32 v254, v254, v223
    v_cmp_eq_u32 vcc, -1, v254
    s_cbranch_vccnz L_retry117
L_back118:
    v_mfma_f32_32x32x16_bf16 v[160:175], v[60:63], v[216:219], v[160:175]
    ds_read_b64_tr_b16 v[56:57], v3
    ds_read_b64_tr_b16 v[58:59], v3 offset:1024
    s_waitcnt lgkmcnt(6)
    s_mul_i32 s69, s70, 8192
    s_mul_i32 s74, s87, 28672
    s_add_u32 s69, s69, s74
    s_add_u32 s69, s69, 40960
    buffer_load_dwordx4 v[152:155], v6, s[20:23], s69 offen sc1
    v_mfma_f32_32x32x16_bf16 v[176:191], v[248:251], v[216:219], v[176:191]
    ds_read_b64_tr_b16 v[60:61], v4
    ds_read_b64_tr_b16 v[62:63], v4 offset:1024
    s_waitcnt lgkmcnt(6)
    buffer_load_dwordx4 v[156:159], v6, s[20:23], s69 offen offset:1024 sc1
    v_mfma_f32_32x32x16_bf16 v[160:175], v[48:51], v[220:223], v[160:175]
    ds_read_b64_tr_b16 v[248:249], v3 offset:2048
    ds_read_b64_tr_b16 v[250:251], v3 offset:3072
    s_waitcnt lgkmcnt(6)
    s_mul_i32 s69, s70, 28672
    s_mul_i32 s74, s64, 57344
    s_add_u32 s69, s69, s74
    s_add_u32 s69, s69, 45056
    buffer_load_dwordx4 v[192:195], v6, s[20:23], s69 offen sc1
    v_mfma_f32_32x32x16_bf16 v[176:191], v[52:55], v[220:223], v[176:191]
    ds_read_b64_tr_b16 v[48:49], v4 offset:2048
    ds_read_b64_tr_b16 v[50:51], v4 offset:3072
    s_waitcnt lgkmcnt(6)
    buffer_load_dwordx4 v[196:199], v6, s[20:23], s69 offen offset:1024 sc1
    v_or_b32 v3, 114688, v14
    v_xor_b32 v4, 114752, v14
    s_barrier
    s_waitcnt vmcnt(10)
    v_max3_u32 v254, v128, v131, v132
    v_max_u32 v254, v254, v135
    v_cmp_eq_u32 vcc, -1, v254
    s_cbranch_vccnz L_retry120
L_back121:
    v_mfma_f32_32x32x16_bf16 v[160:175], v[56:59], v[128:131], v[160:175]
    ds_read_b64_tr_b16 v[52:53], v3
    ds_read_b64_tr_b16 v[54:55], v3 offset:1024
    s_waitcnt lgkmcnt(6)
    s_mul_i32 s69, s70, 28672
    s_mul_i32 s74, s65, 57344
    s_add_u32 s69, s69, s74
    s_add_u32 s69, s69, 45056
    buffer_load_dwordx4 v[200:203], v6, s[20:23], s69 offen sc1
    v_mfma_f32_32x32x16_bf16 v[176:191], v[60:63], v[128:131], v[176:191]
    ds_read_b64_tr_b16 v[56:57], v4
    ds_read_b64_tr_b16 v[58:59], v4 offset:1024
    s_waitcnt lgkmcnt(6)
    buffer_load_dwordx4 v[204:207], v6, s[20:23], s69 offen offset:1024 sc1
    v_mfma_f32_32x32x16_bf16 v[160:175], v[248:251], v[132:135], v[160:175]
    ds_read_b64_tr_b16 v[60:61], v3 offset:2048
    ds_read_b64_tr_b16 v[62:63], v3 offset:3072
    s_waitcnt lgkmcnt(6)
    s_mul_i32 s39, s58, 50176
    s_mul_i32 m0, s84, 100352
    s_add_u32 s39, s39, m0
    s_add_u32 m0, s40, 49152
    s_nop 0
    buffer_load_dwordx4 v10, s[92:95], s39 offen lds
    v_mfma_f32_32x32x16_bf16 v[176:191], v[48:51], v[132:135], v[176:191]
    ds_read_b64_tr_b16 v[248:249], v4 offset:2048
    ds_read_b64_tr_b16 v[250:251], v4 offset:3072
    s_waitcnt lgkmcnt(6)
    buffer_load_dwordx4 v11, s[92:95], s39 offen offset:1024 lds
    v_or_b32 v3, 131072, v14
    v_xor_b32 v4, 131136, v14
    s_barrier
    s_waitcnt vmcnt(12)
    v_max3_u32 v254, v136, v139, v140
    v_max_u32 v254, v254, v143
    v_cmp_eq_u32 vcc, -1, v254
    s_cbranch_vccnz L_retry123
L_back124:
    v_mfma_f32_32x32x16_bf16 v[160:175], v[52:55], v[136:139], v[160:175]
    ds_read_b64_tr_b16 v[48:49], v3
    ds_read_b64_tr_b16 v[50:51], v3 offset:1024
    s_waitcnt lgkmcnt(6)
    s_mul_i32 s39, s58, 50176
    s_mul_i32 m0, s85, 100352
    s_add_u32 s39, s39, m0
    s_add_u32 m0, s40, 65536
    s_nop 0
    buffer_load_dwordx4 v10, s[92:95], s39 offen lds
    v_mfma_f32_32x32x16_bf16 v[176:191], v[56:59], v[136:139], v[176:191]
    ds_read_b64_tr_b16 v[52:53], v4
    ds_read_b64_tr_b16 v[54:55], v4 offset:1024
    s_waitcnt lgkmcnt(6)
    buffer_load_dwordx4 v11, s[92:95], s39 offen offset:1024 lds
    v_mfma_f32_32x32x16_bf16 v[160:175], v[60:63], v[140:143], v[160:175]
    ds_read_b64_tr_b16 v[56:57], v3 offset:2048
    ds_read_b64_tr_b16 v[58:59], v3 offset:3072
    s_waitcnt lgkmcnt(6)
    s_mul_i32 s39, s58, 50176
    s_mul_i32 m0, s86, 100352
    s_add_u32 s39, s39, m0
    s_add_u32 m0, s40, 81920
    s_nop 0
    buffer_load_dwordx4 v10, s[92:95], s39 offen lds
    v_mfma_f32_32x32x16_bf16 v[176:191], v[248:251], v[140:143], v[176:191]
    ds_read_b64_tr_b16 v[60:61], v4 offset:2048
    ds_read_b64_tr_b16 v[62:63], v4 offset:3072
    s_waitcnt lgkmcnt(6)
    buffer_load_dwordx4 v11, s[92:95], s39 offen offset:1024 lds
    v_or_b32 v3, 0, v14
    v_xor_b32 v4, 64, v14
    s_barrier
    s_waitcnt vmcnt(14)
    v_max3_u32 v254, v144, v147, v148
    v_max_u32 v254, v254, v151
    v_cmp_eq_u32 vcc, -1, v254
    s_cbranch_vccnz L_retry126
L_back127:
    v_mfma_f32_32x32x16_bf16 v[160:175], v[48:51], v[144:147], v[160:175]
    ds_read_b64_tr_b16 v[248:249], v3
    ds_read_b64_tr_b16 v[250:251], v3 offset:1024
    s_waitcnt lgkmcnt(6)
    s_mul_i32 s39, s58, 50176
    s_mul_i32 m0, s87, 100352
    s_add_u32 s39, s39, m0
    s_add_u32 m0, s40, 98304
    s_nop 0
    buffer_load_dwordx4 v10, s[92:95], s39 offen lds
    v_mfma_f32_32x32x16_bf16 v[176:191], v[52:55], v[144:147], v[176:191]
    ds_read_b64_tr_b16 v[48:49], v4
    ds_read_b64_tr_b16 v[50:51], v4 offset:1024
    s_waitcnt lgkmcnt(6)
    buffer_load_dwordx4 v11, s[92:95], s39 offen offset:1024 lds
    v_mfma_f32_32x32x16_bf16 v[160:175], v[56:59], v[148:151], v[160:175]
    ds_read_b64_tr_b16 v[52:53], v3 offset:2048
    ds_read_b64_tr_b16 v[54:55], v3 offset:3072
    s_waitcnt lgkmcnt(6)
    v_mfma_f32_32x32x16_bf16 v[176:191], v[60:63], v[148:151], v[176:191]
    ds_read_b64_tr_b16 v[56:57], v4 offset:2048
    ds_read_b64_tr_b16 v[58:59], v4 offset:3072
    s_waitcnt lgkmcnt(6)
    v_or_b32 v3, 16384, v14
    v_xor_b32 v4, 16448, v14
    s_barrier
    s_waitcnt vmcnt(12)
    v_max3_u32 v254, v152, v155, v156
    v_max_u32 v254, v254, v159
    v_cmp_eq_u32 vcc, -1, v254
    s_cbranch_vccnz L_retry129
L_back130:
    v_mfma_f32_32x32x16_bf16 v[160:175], v[248:251], v[152:155], v[160:175]
    ds_read_b64_tr_b16 v[60:61], v3
    ds_read_b64_tr_b16 v[62:63], v3 offset:1024
    s_waitcnt lgkmcnt(6)
    v_mfma_f32_32x32x16_bf16 v[176:191], v[48:51], v[152:155], v[176:191]
    ds_read_b64_tr_b16 v[248:249], v4
    ds_read_b64_tr_b16 v[250:251], v4 offset:1024
    s_waitcnt lgkmcnt(6)
    v_mfma_f32_32x32x16_bf16 v[160:175], v[52:55], v[156:159], v[160:175]
    ds_read_b64_tr_b16 v[48:49], v3 offset:2048
    ds_read_b64_tr_b16 v[50:51], v3 offset:3072
    s_waitcnt lgkmcnt(6)
    v_mfma_f32_32x32x16_bf16 v[176:191], v[56:59], v[156:159], v[176:191]
    ds_read_b64_tr_b16 v[52:53], v4 offset:2048
    ds_read_b64_tr_b16 v[54:55], v4 offset:3072
    s_waitcnt lgkmcnt(6)
    v_or_b32 v3, 32768, v14
    v_xor_b32 v4, 32832, v14
    s_barrier
    s_waitcnt vmcnt(10)
    v_max3_u32 v254, v192, v195, v196
    v_max_u32 v254, v254, v199
    v_cmp_eq_u32 vcc, -1, v254
    s_cbranch_vccnz L_retry132
L_back133:
    v_mfma_f32_32x32x16_bf16 v[160:175], v[60:63], v[192:195], v[160:175]
    ds_read_b64_tr_b16 v[56:57], v3
    ds_read_b64_tr_b16 v[58:59], v3 offset:1024
    s_waitcnt lgkmcnt(6)
    v_and_b32 v2, 31, v1
    v_lshlrev_b32 v2, 2, v2
    buffer_load_dword v5, v2, s[20:23], s79 offen sc1
    v_mfma_f32_32x32x16_bf16 v[176:191], v[248:251], v[192:195], v[176:191]
    ds_read_b64_tr_b16 v[60:61], v4
    ds_read_b64_tr_b16 v[62:63], v4 offset:1024
    s_waitcnt lgkmcnt(6)
    s_mul_i32 s69, s70, 4096
    s_mul_i32 s74, s84, 8192
    s_add_u32 s69, s69, s74
    buffer_load_dwordx4 v[208:211], v6, s[20:23], s69 offen sc1
    v_mfma_f32_32x32x16_bf16 v[160:175], v[48:51], v[196:199], v[160:175]
    ds_read_b64_tr_b16 v[248:249], v3 offset:2048
    ds_read_b64_tr_b16 v[250:251], v3 offset:3072
    s_waitcnt lgkmcnt(6)
    buffer_load_dwordx4 v[212:215], v6, s[20:23], s69 offen offset:1024 sc1
    v_mfma_f32_32x32x16_bf16 v[176:191], v[52:55], v[196:199], v[176:191]
    ds_read_b64_tr_b16 v[48:49], v4 offset:2048
    ds_read_b64_tr_b16 v[50:51], v4 offset:3072
    s_waitcnt lgkmcnt(6)
    s_mul_i32 s69, s70, 4096
    s_mul_i32 s74, s85, 8192
    s_add_u32 s69, s69, s74
    buffer_load_dwordx4 v[216:219], v6, s[20:23], s69 offen sc1
    v_or_b32 v3, 49152, v14
    v_xor_b32 v4, 49216, v14
    s_waitcnt vmcnt(10)
    s_barrier
    v_max3_u32 v254, v200, v203, v204
    v_max_u32 v254, v254, v207
    v_cmp_eq_u32 vcc, -1, v254
    s_cbranch_vccnz L_retry135
L_back136:
    v_mfma_f32_32x32x16_bf16 v[160:175], v[56:59], v[200:203], v[160:175]
    ds_read_b64_tr_b16 v[52:53], v3
    ds_read_b64_tr_b16 v[54:55], v3 offset:1024
    s_waitcnt lgkmcnt(6)
    buffer_load_dwordx4 v[220:223], v6, s[20:23], s69 offen offset:1024 sc1
    v_mfma_f32_32x32x16_bf16 v[176:191], v[60:63], v[200:203], v[176:191]
    ds_read_b64_tr_b16 v[56:57], v4
    ds_read_b64_tr_b16 v[58:59], v4 offset:1024
    s_waitcnt lgkmcnt(6)
    s_mul_i32 s69, s70, 4096
    s_mul_i32 s74, s86, 8192
    s_add_u32 s69, s69, s74
    buffer_load_dwordx4 v[128:131], v6, s[20:23], s69 offen sc1
    v_mfma_f32_32x32x16_bf16 v[160:175], v[248:251], v[204:207], v[160:175]
    ds_read_b64_tr_b16 v[60:61], v3 offset:2048
    ds_read_b64_tr_b16 v[62:63], v3 offset:3072
    s_waitcnt lgkmcnt(6)
    buffer_load_dwordx4 v[132:135], v6, s[20:23], s69 offen offset:1024 sc1
    v_mfma_f32_32x32x16_bf16 v[176:191], v[48:51], v[204:207], v[176:191]
    ds_read_b64_tr_b16 v[248:249], v4 offset:2048
    ds_read_b64_tr_b16 v[250:251], v4 offset:3072
    s_waitcnt lgkmcnt(6)
    s_mul_i32 s69, s70, 4096
    s_mul_i32 s74, s87, 8192
    s_add_u32 s69, s69, s74
    buffer_load_dwordx4 v[136:139], v6, s[20:23], s69 offen sc1
    v_or_b32 v3, 65536, v14
    v_xor_b32 v4, 65600, v14
    s_waitcnt vmcnt(12)
    s_barrier
    s_waitcnt vmcnt(5)
    v_max3_u32 v254, v208, v211, v212
    v_max_u32 v254, v254, v215
    v_cmp_eq_u32 vcc, -1, v254
    s_cbranch_vccnz L_retry138
L_back139:
    v_cmp_eq_u32 vcc, -1, v5
    s_cbranch_vccnz L_retry102
L_back103:
    v_mul_f32 v160, v160, v5
    v_mul_f32 v161, v161, v5
    v_mul_f32 v162, v162, v5
    v_mul_f32 v163, v163, v5
    v_mul_f32 v164, v164, v5
    v_mul_f32 v165, v165, v5
    v_mul_f32 v166, v166, v5
    v_mul_f32 v167, v167, v5
    v_mul_f32 v168, v168, v5
    v_mul_f32 v169, v169, v5
    v_mul_f32 v170, v170, v5
    v_mul_f32 v171, v171, v5
    v_mul_f32 v172, v172, v5
    v_mul_f32 v173, v173, v5
    v_mul_f32 v174, v174, v5
    v_mul_f32 v175, v175, v5
    v_mul_f32 v176, v176, v5
    v_mul_f32 v177, v177, v5
    v_mul_f32 v178, v178, v5
    v_mul_f32 v179, v179, v5
    v_mul_f32 v180, v180, v5
    v_mul_f32 v181, v181, v5
    v_mul_f32 v182, v182, v5
    v_mul_f32 v183, v183, v5
    v_mul_f32 v184, v184, v5
    v_mul_f32 v185, v185, v5
    v_mul_f32 v186, v186, v5
    v_mul_f32 v187, v187, v5
    v_mul_f32 v188, v188, v5
    v_mul_f32 v189, v189, v5
    v_mul_f32 v190, v190, v5
    v_mul_f32 v191, v191, v5
    v_mfma_f32_32x32x16_bf16 v[160:175], v[52:55], v[208:211], v[160:175]
    ds_read_b64_tr_b16 v[48:49], v3
    ds_read_b64_tr_b16 v[50:51], v3 offset:1024
    s_waitcnt lgkmcnt(6)
    buffer_load_dwordx4 v[140:143], v6, s[20:23], s69 offen offset:1024 sc1
    v_mfma_f32_32x32x16_bf16 v[176:191], v[56:59], v[208:211], v[176:191]
    ds_read_b64_tr_b16 v[52:53], v4
    ds_read_b64_tr_b16 v[54:55], v4 offset:1024
    s_waitcnt lgkmcnt(6)
    v_and_b32 v20, 31, v1
    v_and_b32 v19, 7, v1
    v_lshrrev_b32 v23, 5, v1
    v_xor_b32 v19, v19, v23
    v_lshlrev_b32 v19, 4, v19
    v_lshl_add_u32 v20, v20, 8, v19
    s_lshl_b32 s71, s3, 13
    s_add_u32 s71, s71, 0
    v_add_u32 v20, s71, v20
    v_xor_b32 v24, 0, v20
    v_xor_b32 v25, 32, v20
    v_xor_b32 v26, 64, v20
    v_xor_b32 v27, 96, v20
    v_xor_b32 v28, 128, v20
    v_xor_b32 v29, 160, v20
    v_xor_b32 v30, 192, v20
    v_mfma_f32_32x32x16_bf16 v[160:175], v[60:63], v[212:215], v[160:175]
    ds_read_b64_tr_b16 v[56:57], v3 offset:2048
    ds_read_b64_tr_b16 v[58:59], v3 offset:3072
    s_waitcnt lgkmcnt(6)
    v_xor_b32 v31, 224, v20
    v_lshrrev_b32 v23, 3, v1
    v_and_b32 v19, 7, v1
    v_lshlrev_b32 v21, 1, v19
    v_xor_b32 v21, v21, v23
    v_lshlrev_b32 v21, 4, v21
    v_lshl_add_u32 v21, v23, 8, v21
    s_lshl_b32 s71, s58, 15
    s_and_b32 s50, s3, 3
    s_lshl_b32 s72, s50, 11
    s_add_u32 s71, s71, s72
    s_add_u32 s71, s71, 0
    v_add_u32 v21, s71, v21
    v_xor_b32 v22, 16, v21
    v_mul_u32_u24 v23, 896, v23
    v_lshl_add_u32 v23, v19, 4, v23
    s_lshl_b32 s71, s61, 6
    s_lshl_b32 s72, s58, 5
    s_add_u32 s71, s71, s72
    s_lshl_b32 s72, s50, 3
    s_add_u32 s71, s71, s72
    s_mul_i32 s71, s71, 896
    s_lshl_b32 s72, s62, 7
    s_add_u32 s71, s71, s72
    v_mfma_f32_32x32x16_bf16 v[176:191], v[248:251], v[212:215], v[176:191]
    ds_read_b64_tr_b16 v[60:61], v4 offset:2048
    ds_read_b64_tr_b16 v[62:63], v4 offset:3072
    s_waitcnt lgkmcnt(6)
    v_xor_b32 v3, 81920, v14
    s_barrier
    s_waitcnt vmcnt(4)
    v_max3_u32 v254, v216, v219, v220
    v_max_u32 v254, v254, v223
    v_cmp_eq_u32 vcc, -1, v254
    s_cbranch_vccnz L_retry141
L_back142:
    v_mfma_f32_32x32x16_bf16 v[160:175], v[48:51], v[216:219], v[160:175]
    ds_read_b64_tr_b16 v[248:249], v3
    ds_read_b64_tr_b16 v[250:251], v3 offset:1024
    s_waitcnt lgkmcnt(6)
    v_mfma_f32_32x32x16_bf16 v[176:191], v[52:55], v[216:219], v[176:191]
    ds_read_b64_tr_b16 v[48:49], v3 offset:2048
    ds_read_b64_tr_b16 v[50:51], v3 offset:3072
    s_waitcnt lgkmcnt(6)
    v_xor_b32 v4, 98304, v14
    v_mfma_f32_32x32x16_bf16 v[160:175], v[56:59], v[220:223], v[160:175]
    ds_read_b64_tr_b16 v[52:53], v4
    ds_read_b64_tr_b16 v[54:55], v4 offset:1024
    s_waitcnt lgkmcnt(6)
    v_mfma_f32_32x32x16_bf16 v[176:191], v[60:63], v[220:223], v[176:191]
    ds_read_b64_tr_b16 v[56:57], v4 offset:2048
    ds_read_b64_tr_b16 v[58:59], v4 offset:3072
    s_waitcnt lgkmcnt(6)
    v_xor_b32 v3, 81984, v14
    s_waitcnt vmcnt(2)
    v_max3_u32 v254, v128, v131, v132
    s_waitcnt vmcnt(1)
    v_max3_u32 v254, v254, v135, v136
    s_waitcnt vmcnt(0)
    v_max3_u32 v254, v254, v139, v140
    v_max_u32 v254, v254, v143
    v_cmp_eq_u32 vcc, -1, v254
    s_cbranch_vccnz L_retry144
L_back145:
    v_mfma_f32_32x32x16_bf16 v[160:175], v[248:251], v[128:131], v[160:175]
    ds_read_b64_tr_b16 v[60:61], v3
    ds_read_b64_tr_b16 v[62:63], v3 offset:1024
    s_waitcnt lgkmcnt(6)
    v_mfma_f32_32x32x16_bf16 v[160:175], v[48:51], v[132:135], v[160:175]
    ds_read_b64_tr_b16 v[248:249], v3 offset:2048
    ds_read_b64_tr_b16 v[250:251], v3 offset:3072
    s_waitcnt lgkmcnt(6)
    v_xor_b32 v4, 98368, v14
    v_mfma_f32_32x32x16_bf16 v[160:175], v[52:55], v[136:139], v[160:175]
    ds_read_b64_tr_b16 v[48:49], v4
    ds_read_b64_tr_b16 v[50:51], v4 offset:1024
    s_waitcnt lgkmcnt(6)
    v_mfma_f32_32x32x16_bf16 v[160:175], v[56:59], v[140:143], v[160:175]
    ds_read_b64_tr_b16 v[52:53], v4 offset:2048
    ds_read_b64_tr_b16 v[54:55], v4 offset:3072
    s_waitcnt lgkmcnt(6)
    v_mfma_f32_32x32x16_bf16 v[176:191], v[60:63], v[128:131], v[176:191]
    s_waitcnt lgkmcnt(4)
    v_mfma_f32_32x32x16_bf16 v[176:191], v[248:251], v[132:135], v[176:191]
    s_waitcnt lgkmcnt(2)
    s_nop 4
    ds_write_b128 v24, v[160:163]
    ds_write_b128 v25, v[164:167]
    v_mfma_f32_32x32x16_bf16 v[176:191], v[48:51], v[136:139], v[176:191]
    s_waitcnt lgkmcnt(2)
    ds_write_b128 v26, v[168:171]
    ds_write_b128 v27, v[172:175]
    v_mfma_f32_32x32x16_bf16 v[176:191], v[52:55], v[140:143], v[176:191]
    s_nop 11
    ds_write_b128 v28, v[176:179]
    ds_write_b128 v29, v[180:183]
    ds_write_b128 v30, v[184:187]
    ds_write_b128 v31, v[188:191]
    s_waitcnt lgkmcnt(0)
    s_barrier
    ds_read_b128 v[64:67], v21
    ds_read_b128 v[68:71], v22
    ds_read_b128 v[72:75], v21 offset:8192
    ds_read_b128 v[76:79], v22 offset:8192
    ds_read_b128 v[80:83], v21 offset:16384
    ds_read_b128 v[84:87], v22 offset:16384
    ds_read_b128 v[88:91], v21 offset:24576
    ds_read_b128 v[92:95], v22 offset:24576
    s_waitcnt lgkmcnt(5)
    v_add_f32 v64, v64, v72
    v_add_f32 v65, v65, v73
    v_add_f32 v66, v66, v74
    v_add_f32 v67, v67, v75
    s_waitcnt lgkmcnt(4)
    v_add_f32 v68, v68, v76
    v_add_f32 v69, v69, v77
    v_add_f32 v70, v70, v78
    v_add_f32 v71, v71, v79
    s_waitcnt lgkmcnt(1)
    v_add_f32 v80, v80, v88
    v_add_f32 v81, v81, v89
    v_add_f32 v82, v82, v90
    v_add_f32 v83, v83, v91
    s_waitcnt lgkmcnt(0)
    v_add_f32 v84, v84, v92
    v_add_f32 v85, v85, v93
    v_add_f32 v86, v86, v94
    v_add_f32 v87, v87, v95
    v_add_f32 v64, v64, v80
    v_add_f32 v65, v65, v81
    v_add_f32 v66, v66, v82
    v_add_f32 v67, v67, v83
    v_add_f32 v68, v68, v84
    v_add_f32 v69, v69, v85
    v_add_f32 v70, v70, v86
    v_add_f32 v71, v71, v87
    v_cvt_pk_bf16_f32 v96, v64, v65
    v_cvt_pk_bf16_f32 v97, v66, v67
    v_cvt_pk_bf16_f32 v98, v68, v69
    v_cvt_pk_bf16_f32 v99, v70, v71
    buffer_store_dwordx4 v[96:99], v23, s[96:99], s71 offen
    s_endpgm
L_end:
    s_endpgm
.section .rodata,"a"
.p2align 6
.amdhsa_kernel gated_mix__linear_kernel_hedgehog__glu_gated_geglu__prompt_kernel
  .amdhsa_next_free_vgpr 256
  .amdhsa_next_free_sgpr 102
  .amdhsa_accum_offset 256
  .amdhsa_group_segment_fixed_size 0
  .amdhsa_kernarg_size 96
  .amdhsa_user_sgpr_count 2
  .amdhsa_user_sgpr_kernarg_segment_ptr 1
  .amdhsa_system_sgpr_workgroup_id_x 1
.end_amdhsa_kernel
```
